```python
import torch

def _softmax(x, axis=-1):
    return torch.softmax(x, dim=axis)
def _gelu(x):
    return torch.nn.functional.gelu(x, approximate="tanh")
def _silu(x):
    return torch.nn.functional.silu(x)
def _sigmoid(x):
    return torch.sigmoid(x)
def _layernorm(x, axis=-1, eps=1e-5):
    m = x.mean(dim=axis, keepdim=True)
    v = x.var(dim=axis, keepdim=True, unbiased=False)
    return (x - m) / torch.sqrt(v + eps)
def _scatter_add(tgt, idx, src, axis=0):
    return tgt.clone().index_add_(axis, idx, src)
def _segment_sum(src, seg, n):
    out = torch.zeros((n,) + src.shape[1:], dtype=src.dtype)
    return out.index_add_(0, seg, src)
def _pad(x, pw):
    flat = tuple(v for pair in reversed(pw) for v in pair)
    return torch.nn.functional.pad(x, flat)

kernel_name = 'sequential_preLN__sliding_block__glu_gated_glu__prompt'

def setup_inputs():

    _w = (lambda a: (lambda t: t.to(torch.bfloat16) if t.is_floating_point() else t)(torch.as_tensor(a)))
    def _A_setup():
        B, S, D = 1, 2048, 512
        return {
            "x": _w((lambda *s: torch.randn(*s, dtype=torch.bfloat16) * 0.05)(B, S, D)),
            "wqkv": _w((lambda *s: torch.randn(*s, dtype=torch.bfloat16) * 0.05)(D, 3 * D)),
            "wo": _w((lambda *s: torch.randn(*s, dtype=torch.bfloat16) * 0.05)(D, D)),
        }
    _A_in = _A_setup()

    def _B_setup():
        B, S, D, F = 1, 2048, 512, 1792
        return {
            "x": _w((lambda *s: torch.randn(*s, dtype=torch.bfloat16) * 0.05)(B, S, D)),
            "w_gate": _w((lambda *s: torch.randn(*s, dtype=torch.bfloat16) * 0.05)(D, F)),
            "w_up": _w((lambda *s: torch.randn(*s, dtype=torch.bfloat16) * 0.05)(D, F)),
            "w_down": _w((lambda *s: torch.randn(*s, dtype=torch.bfloat16) * 0.05)(F, D)),
        }
    _B_in = _B_setup()

    return {
        "A_x": _A_in["x"],
        "A_wqkv": _A_in["wqkv"],
        "A_wo": _A_in["wo"],
        "B_x": _B_in["x"],
        "B_w_gate": _B_in["w_gate"],
        "B_w_up": _B_in["w_up"],
        "B_w_down": _B_in["w_down"],
    }

def reference(A_x, A_wqkv, A_wo, B_x, B_w_gate, B_w_up, B_w_down):
    def _A_ref(x, wqkv, wo):
        B, S, D = x.shape
        H = 32; Dh = D // H; W = 256
        qkv = (lambda x, *d: x.permute(*d))((x @ wqkv).reshape(B, S, 3, H, Dh), 2, 0, 3, 1, 4)
        q, k, v = qkv[0], qkv[1], qkv[2]
        scores = torch.einsum("bhqd,bhkd->bhqk", q, k) * (Dh ** -0.5)
        idx = torch.arange(S)
        mask = (idx[:, None] - idx[None, :] >= 0) & (idx[:, None] - idx[None, :] < W)
        scores = torch.where(mask[None, None], scores, -1e9)
        p = _softmax(scores, axis=-1)
        o = torch.einsum("bhqk,bhkd->bhqd", p, v)
        return (lambda x, *d: x.permute(*d))(o, 0, 2, 1, 3).reshape(B, S, D) @ wo

    def _B_ref(x, w_gate, w_up, w_down):
        g = torch.einsum("bsd,df->bsf", x, w_gate)
        u = torch.einsum("bsd,df->bsf", x, w_up)
        h = _sigmoid(g) * u
        return torch.einsum("bsf,fd->bsd", h, w_down)

    x = A_x
    h = x + _A_ref(_layernorm(x, axis=-1), A_wqkv, A_wo)
    h2 = h + _B_ref(_layernorm(h, axis=-1), B_w_gate, B_w_up, B_w_down)
    return h2
```

```asm
; @launch grid=(256,1,1) block=(256,1,1) lds=163840
.amdgcn_target "amdgcn-amd-amdhsa--gfx950"
.text
.globl sequential_preLN__sliding_block__glu_gated_glu__prompt_kernel
.p2align 8
.type sequential_preLN__sliding_block__glu_gated_glu__prompt_kernel,@function
sequential_preLN__sliding_block__glu_gated_glu__prompt_kernel:
s_cmpk_ge_u32 s2, 256
s_cbranch_scc1 L_end
s_load_dwordx2 s[4:5], s[0:1], 0
s_load_dwordx2 s[8:9], s[0:1], 8
s_load_dwordx2 s[12:13], s[0:1], 72
s_load_dwordx2 s[16:17], s[0:1], 16
s_load_dwordx2 s[18:19], s[0:1], 64
s_load_dwordx8 s[20:27], s[0:1], 32
s_getpc_b64 s[40:41]
L_pc:
s_lshr_b32 s3, s2, 3
v_lshl_add_u32 v2, s3, 8, v0
v_lshlrev_b32 v2, 2, v2
v_min_u32 v2, L_tab-L_pc, v2
global_load_dword v38, v2, s[40:41]
v_lshrrev_b32 v2, 6, v0
v_bfe_u32 v40, v0, 3, 3
v_readfirstlane_b32 s28, v2
v_and_b32 v41, 7, v0
v_bfe_u32 v42, v0, 4, 2
s_and_b32 s3, s2, 6
s_lshr_b32 s29, s2, 5
s_lshl2_add_u32 s29, s3, s29
s_and_b32 s3, s2, 1
s_bfe_u32 s30, s2, 0x20003
s_lshl2_add_u32 s30, s3, s30
s_lshl2_add_u32 s43, s29, s28
s_lshl_b32 s43, s43, 14
v_lshl_add_u32 v43, v40, 10, s43
v_xor_b32 v44, v41, v42
v_lshl_add_u32 v2, v44, 4, v43
v_xor_b32 v3, 64, v2
v_add_u32 v3, 7168, v3
v_and_b32 v45, 16, v0
v_lshlrev_b32 v45, 2, v45
v_lshlrev_b32 v44, 4, v41
v_xor_b32 v45, v45, v44
s_mul_i32 s42, s28, 49152
s_lshl_b32 s43, s30, 7
s_add_u32 s42, s42, s43
s_addk_i32 s42, 3072
v_mul_u32_u24 v43, 3072, v40
v_add3_u32 v4, v43, v45, s42
v_add_u32 v5, 23552, v4
s_lshl_b32 s36, s28, 12
s_add_u32 s3, s29, s30
s_mul_i32 s3, s3, 4
s_and_b32 s3, s3, 7
s_lshl_b32 s34, s3, 7
s_mul_i32 s35, s3, 196608
s_mov_b32 s45, s3
s_mov_b32 s6, 0x200000
s_mov_b32 s7, 0x20000
s_mov_b32 s10, 0x181000
s_mov_b32 s11, 0x20000
s_waitcnt lgkmcnt(0)
s_sub_u32 s8, s8, 4096
s_subb_u32 s9, s9, 0
s_add_u32 m0, s36, 0
s_nop 0
buffer_load_dwordx4 v2, s[4:7], s34 offen  lds
buffer_load_dwordx4 v3, s[4:7], s34 offen offset:1024  lds
buffer_load_dwordx4 v4, s[8:11], s35 offen offset:2048  lds
buffer_load_dwordx4 v5, s[8:11], s35 offen offset:3072  lds
s_add_u32 m0, s36, 16384
s_add_u32 s34, s34, 128
s_and_b32 s34, s34, 1023
s_mul_i32 s35, s34, 1536
buffer_load_dwordx4 v2, s[4:7], s34 offen  lds
buffer_load_dwordx4 v3, s[4:7], s34 offen offset:1024  lds
buffer_load_dwordx4 v4, s[8:11], s35 offen offset:2048  lds
buffer_load_dwordx4 v5, s[8:11], s35 offen offset:3072  lds
s_add_u32 m0, s36, 32768
s_add_u32 s34, s34, 128
s_and_b32 s34, s34, 1023
s_mul_i32 s35, s34, 1536
buffer_load_dwordx4 v2, s[4:7], s34 offen  lds
buffer_load_dwordx4 v3, s[4:7], s34 offen offset:1024  lds
buffer_load_dwordx4 v4, s[8:11], s35 offen offset:2048  lds
buffer_load_dwordx4 v5, s[8:11], s35 offen offset:3072  lds
s_add_u32 s40, s40, L_tab-L_pc
s_addc_u32 s41, s41, 0
s_load_dwordx16 s[48:63], s[40:41], 0
s_load_dwordx16 s[64:79], s[40:41], 64
s_load_dwordx8 s[80:87], s[40:41], 128
s_mov_b32 s14, 0x2000000
s_mov_b32 s15, 0x20000
v_lshl_add_u32 v54, s2, 8, v0
v_lshrrev_b32 v28, 7, v54
v_mul_u32_u24 v28, 3072, v28
v_and_b32 v29, 64, v54
v_lshl_add_u32 v28, v29, 5, v28
v_and_b32 v29, 63, v54
v_lshl_add_u32 v28, v29, 4, v28
v_add_u32 v28, 4096, v28
v_lshlrev_b32 v29, 3, v54
v_and_b32 v0, 63, v0
s_or_b32 s3, s2, s28
s_cbranch_scc1 L_noep1
s_load_dwordx2 s[38:39], s[12:13], 0 glc
s_waitcnt lgkmcnt(0)
s_add_u32 s38, s38, 1
s_or_b32 s39, s39, 1
v_mov_b32 v46, s38
v_mov_b32 v47, s39
v_mov_b32 v48, 0
s_mov_b64 exec, 1
global_store_dwordx2 v48, v[46:47], s[18:19] sc1
global_store_dwordx2 v48, v[46:47], s[12:13] sc1
s_mov_b64 exec, -1
L_noep1:
v_lshlrev_b32 v1, 4, v0
v_and_b32 v46, 31, v0
v_lshrrev_b32 v47, 5, v0
v_and_b32 v48, 15, v0
s_mov_b32 s37, 0
s_lshl3_add_u32 s33, s29, s30
s_and_b32 s42, s28, 1
s_lshr_b32 s43, s28, 1
v_lshrrev_b32 v49, 4, v46
s_lshl_b32 s3, s42, 1
v_add_u32 v49, s3, v49
v_lshlrev_b32 v49, 12, v49
v_lshl_add_u32 v49, v48, 7, v49
v_bfe_u32 v50, v0, 1, 3
s_lshl_b32 s3, s28, 1
v_add_u32 v51, s3, v47
v_xor_b32 v50, v50, v51
v_lshl_add_u32 v6, v50, 4, v49
v_xor_b32 v7, 32, v6
v_xor_b32 v8, 64, v6
v_xor_b32 v9, 96, v6
v_lshrrev_b32 v49, 2, v48
v_lshl_add_u32 v50, v47, 3, v49
v_lshlrev_b32 v50, 7, v50
v_lshrrev_b32 v51, 3, v48
v_xor_b32 v52, s43, v51
v_lshl_add_u32 v50, v52, 6, v50
v_and_b32 v52, 1, v42
v_lshl_add_u32 v50, v52, 5, v50
v_and_b32 v53, 3, v0
v_lshl_add_u32 v50, v53, 3, v50
v_add_u32 v10, s36, v50
v_xor_b32 v11, 4096, v10
v_xor_b32 v12, 8192, v10
v_xor_b32 v13, 12288, v10
v_and_b32 v50, 0x7f0, v6
v_lshl_add_u32 v63, v52, 3, v50
v_cmp_eq_u32 vcc, v49, v42
v_mov_b32 v50, 0x3f803f80
s_nop 0
v_cndmask_b32 v16, 0, v50, vcc
v_mov_b32 v17, v16
v_mov_b32 v18, v16
v_mov_b32 v19, v16
s_mov_b32 s101, s30
s_xor_b32 s30, s30, 1
s_sub_u32 s45, s30, s45
s_and_b32 s45, s45, 7
s_and_b32 s0, s2, 4
s_lshr_b32 s3, s2, 6
s_add_u32 s31, s0, s3
s_xor_b32 s42, s3, 3
s_and_b32 s3, s2, 3
s_mul_i32 s32, s3, 7
s_bfe_u32 s3, s2, 0x30003
s_xor_b32 s3, s3, s42
s_add_u32 s32, s32, s3
s_cmp_lt_u32 s3, 7
s_cselect_b32 s90, 0, 0x80000000
s_cselect_b32 s42, 0, 4
s_cselect_b32 s43, 0, -1
s_xor_b32 s0, s0, s42
s_add_u32 s3, s2, 3
s_and_b32 s3, s3, 3
s_bfe_u32 s42, s2, 0x10006
s_lshl2_add_u32 s3, s42, s3
s_bfe_u32 s42, s2, 0x10007
s_lshl_b32 s42, s42, 1
s_xor_b32 s3, s3, s42
s_min_u32 s3, s3, 6
s_sub_u32 s3, 7, s3
s_and_b32 s3, s3, s43
s_sub_u32 s32, s32, s3
s_lshl_b32 s3, s28, 9
s_add_u32 s3, s3, 98304
v_lshl_add_u32 v33, v0, 3, s3
s_lshl_b32 s3, s28, 7
s_add_u32 s3, s3, 100352
v_lshl_add_u32 v254, v46, 2, s3
v_lshl_add_u32 v255, v47, 4, s3
s_lshl_b32 s3, s33, 10
s_add_u32 s3, s3, 0x40000
s_cmp_eq_u32 s28, 0
s_cselect_b32 s3, s3, 0x80000000
v_lshl_add_u32 v50, v41, 7, s3
v_mov_b32 v44, 0x80000000
v_cmp_eq_u32 vcc, 0, v0
s_lshl_b32 s3, s31, 5
s_add_u32 s3, s3, s32
s_lshl2_add_u32 s3, s3, s28
v_cndmask_b32 v36, v44, v50, vcc
s_lshl_b32 s3, s3, 9
s_add_u32 s3, s3, 0x80000
s_or_b32 s3, s3, s90
v_lshl_add_u32 v51, v53, 7, s3
v_cndmask_b32 v62, v44, v51, vcc
v_mov_b32 v30, v50
v_mov_b32 v31, v51
s_nop 0
s_nop 0
v_lshrrev_b32 v51, 3, v48
v_lshl_add_u32 v50, v47, 2, v49
v_lshl_add_u32 v50, v50, 1, v51
v_and_b32 v54, 1, v0
v_lshl_add_u32 v50, v50, 1, v54
v_lshl_add_u32 v50, v50, 1, v52
v_lshrrev_b32 v54, 1, v53
v_lshl_add_u32 v50, v50, 1, v54
s_lshl_b32 s3, s28, 11
s_add_u32 s3, s3, 114688
v_lshl_add_u32 v50, v50, 3, s3
v_accvgpr_write_b32 a132, v50
v_lshl_add_u32 v50, v47, 2, v52
v_lshl_add_u32 v50, v50, 2, v49
v_lshlrev_b32 v54, 1, v51
v_xor_b32 v54, s28, v54
v_lshl_add_u32 v50, v50, 2, v54
v_lshl_add_u32 v50, v50, 2, v53
v_lshlrev_b32 v50, 3, v50
v_accvgpr_write_b32 a133, v50
s_sub_u32 s3, s29, 4
v_add_u32 v50, s3, v0
v_max_i32 v50, 0, v50
s_add_u32 s3, s101, 0x100
v_lshl_add_u32 v50, v50, 3, s3
v_lshlrev_b32 v50, 10, v50
v_cmp_gt_u32 vcc, 4, v0
s_nop 1
v_cndmask_b32 v248, v44, v50, vcc
v_lshlrev_b32 v50, 8, v47
v_lshl_add_u32 v50, v48, 4, v50
s_mul_i32 s3, s28, 10240
s_add_u32 s3, s3, 122880
v_add_u32 v249, s3, v50
v_lshl_add_u32 v251, v52, 16, v50
s_and_b32 s42, s28, 1
s_lshr_b32 s43, s28, 1
s_lshl_b32 s44, s42, 10
s_mul_i32 s3, s43, 20480
s_add_u32 s3, s3, s44
s_add_u32 s3, s3, 131072
v_mul_u32_u24 v54, 10240, v52
v_add3_u32 v250, v54, v50, s3
s_lshl_b32 s3, s43, 12
s_add_u32 s3, s3, s44
s_add_u32 s3, s3, 106496
v_add_u32 v252, s3, v1
s_lshl_b32 s3, s28, 11
s_add_u32 s3, s3, 106496
v_add_u32 v253, s3, v1
s_lshl_b32 s3, s101, 1
s_add_u32 s3, s3, s43
s_lshl_b32 s3, s3, 17
s_add_u32 s3, s3, s44
s_lshl_b32 s44, s29, 11
s_add_u32 s3, s3, s44
s_add_u32 s46, s3, 0x200000
s_add_u32 s47, s3, 0x400000
s_lshl_b32 s3, s101, 2
s_add_u32 s3, s3, s28
s_lshl_b32 s88, s3, 16
s_lshl_b32 s3, s3, 10
s_lshl_b32 s89, s29, 16
s_add_u32 s89, s89, s3
s_add_u32 s89, s89, 0x600000
s_mul_i32 s3, s28, 57344
s_lshl_b32 s42, s32, 7
s_add_u32 s3, s3, s42
s_or_b32 s3, s3, 0
v_mul_u32_u24 v50, 3584, v40
v_add3_u32 v60, v50, v45, s3
v_add_u32 v61, 27648, v60
v_xor_b32 v50, 32, v60
v_add_u32 v14, 2048, v50
v_add_u32 v15, 27648, v14
v_lshl_add_u32 v50, v40, 10, v45
s_add_u32 m0, s36, 49152
s_add_u32 s34, s34, 128
s_and_b32 s34, s34, 1023
s_mul_i32 s35, s34, 1536
buffer_load_dwordx4 v2, s[4:7], s34 offen  lds
buffer_load_dwordx4 v3, s[4:7], s34 offen offset:1024  lds
buffer_load_dwordx4 v4, s[8:11], s35 offen offset:2048  lds
buffer_load_dwordx4 v5, s[8:11], s35 offen offset:3072  lds
s_waitcnt vmcnt(12)
s_barrier
ds_read_b64_tr_b16 v[96:97], v10 offset:2048
ds_read_b64_tr_b16 v[98:99], v10 offset:2560
ds_read_b128 v[160:163], v6 offset:0
ds_read_b64_tr_b16 v[100:101], v11 offset:2048
ds_read_b64_tr_b16 v[102:103], v11 offset:2560
ds_read_b128 v[164:167], v7 offset:0
ds_read_b64_tr_b16 v[104:105], v12 offset:2048
ds_read_b64_tr_b16 v[106:107], v12 offset:2560
ds_read_b128 a[0:3], v8 offset:0
ds_read_b64_tr_b16 v[108:109], v13 offset:2048
ds_read_b64_tr_b16 v[110:111], v13 offset:2560
ds_read_b128 a[4:7], v9 offset:0
s_waitcnt lgkmcnt(9)
v_mfma_f32_32x32x16_bf16 v[64:79], v[96:99], v[160:163], 0
s_waitcnt lgkmcnt(6)
v_mfma_f32_32x32x16_bf16 v[64:79], v[100:103], v[164:167], v[64:79]
s_waitcnt lgkmcnt(3)
v_mfma_f32_32x32x16_bf16 v[64:79], v[104:107], a[0:3], v[64:79]
s_waitcnt lgkmcnt(0)
v_mfma_f32_32x32x16_bf16 v[64:79], v[108:111], a[4:7], v[64:79]
s_cmp_eq_u32 s45, 0
s_cbranch_scc1 L_res0
L_resb0:
buffer_load_dword v55, v28, s[8:11], 0 offen
global_load_dword v39, v29, s[16:17]
s_mov_b64 exec, 0xff
buffer_load_dword v30, v30, s[12:15], 0 offen
buffer_load_dword v31, v31, s[12:15], 0 offen
s_mov_b64 exec, -1
s_lshl_b32 s3, s30, 7
v_add_u32 v56, s3, v50
v_add_u32 v57, 7168, v56
v_add_u32 v58, 14336, v56
v_add_u32 v59, 21504, v56
s_mul_i32 s42, s29, 37
s_lshr_b32 s42, s42, 8
s_mul_i32 s42, s42, 28
s_lshl2_add_u32 s43, s29, s28
s_sub_u32 s3, s43, s42
s_lshl2_add_u32 s42, s3, s42
s_mul_i32 s3, s3, 37
s_lshr_b32 s3, s3, 8
s_mul_i32 s3, s3, 27
s_sub_u32 s3, s42, s3
s_lshl_b32 s91, s3, 14
s_mul_i32 s3, s30, 112
s_add_u32 s3, s3, s43
s_lshl_b32 s3, s3, 11
s_add_u32 s86, s3, 0x1800000
s_cmp_lt_u32 s29, 28
s_cselect_b32 s91, s91, 0x80000000
s_cselect_b32 s86, s86, 0x80000000
v_mov_b32 v50, 0xffff
v_cndmask_b32 v52, 0, v50, s[48:49]
v_cndmask_b32 v232, v52, -1, s[50:51]
v_cndmask_b32 v52, 0, v50, s[52:53]
v_cndmask_b32 v233, v52, -1, s[54:55]
v_cndmask_b32 v52, 0, v50, s[56:57]
v_cndmask_b32 v234, v52, -1, s[58:59]
v_cndmask_b32 v52, 0, v50, s[60:61]
v_cndmask_b32 v235, v52, -1, s[62:63]
v_cndmask_b32 v52, 0, v50, s[64:65]
v_cndmask_b32 v236, v52, -1, s[66:67]
v_cndmask_b32 v52, 0, v50, s[68:69]
v_cndmask_b32 v237, v52, -1, s[70:71]
v_cndmask_b32 v52, 0, v50, s[72:73]
v_cndmask_b32 v238, v52, -1, s[74:75]
v_cndmask_b32 v52, 0, v50, s[76:77]
v_cndmask_b32 v239, v52, -1, s[78:79]
s_mul_i32 s3, s28, 56
s_add_u32 s3, s3, 0x100
s_and_b32 s43, s33, 7
v_cmp_gt_u32 vcc, 7, v0
s_add_u32 s3, s3, s43
s_lshl_b32 s3, s3, 10
v_lshl_add_u32 v50, v0, 13, s3
v_cndmask_b32 v50, v44, v50, vcc
v_accvgpr_write_b32 a134, v50
s_lshl2_add_u32 s3, s29, s28
v_cmp_gt_u32 vcc, 2, v0
s_lshl_b32 s3, s3, 11
s_add_u32 s3, s3, 0x40000
v_lshl_add_u32 v50, v0, 10, s3
v_cndmask_b32 v50, v44, v50, vcc
v_accvgpr_write_b32 a135, v50
s_waitcnt vmcnt(12)
s_barrier
v_mfma_f32_16x16x32_bf16 v[24:27], v[16:19], v[96:99], 0
ds_read_b64_tr_b16 v[128:129], v10 offset:18432
ds_read_b64_tr_b16 v[130:131], v10 offset:18944
v_mfma_f32_4x4x4_16b_bf16 v[224:227], v[160:161], v[160:161], 0
ds_read_b128 v[168:171], v6 offset:16384
v_mfma_f32_16x16x32_bf16 v[20:23], v[16:19], v[160:163], 0
ds_read_b64_tr_b16 v[132:133], v11 offset:18432
ds_read_b64_tr_b16 v[134:135], v11 offset:18944
v_mfma_f32_4x4x4_16b_bf16 v[224:227], v[162:163], v[162:163], v[224:227]
ds_read_b128 v[172:175], v7 offset:16384
v_mfma_f32_16x16x32_bf16 v[24:27], v[16:19], v[104:107], v[24:27]
ds_read_b64_tr_b16 v[136:137], v12 offset:18432
ds_read_b64_tr_b16 v[138:139], v12 offset:18944
v_mfma_f32_4x4x4_16b_bf16 v[224:227], v[164:165], v[164:165], v[224:227]
ds_read_b128 a[8:11], v8 offset:16384
v_mfma_f32_16x16x32_bf16 v[20:23], v[16:19], v[164:167], v[20:23]
ds_read_b64_tr_b16 v[140:141], v13 offset:18432
ds_read_b64_tr_b16 v[142:143], v13 offset:18944
v_mfma_f32_4x4x4_16b_bf16 v[224:227], v[166:167], v[166:167], v[224:227]
ds_read_b128 a[12:15], v9 offset:16384
s_waitcnt lgkmcnt(9)
v_mfma_f32_32x32x16_bf16 v[64:79], v[128:131], v[168:171], v[64:79]
s_add_u32 m0, s36, 0
s_add_u32 s34, s34, 128
s_and_b32 s34, s34, 1023
s_mul_i32 s35, s34, 1536
buffer_load_dwordx4 v2, s[4:7], s34 offen  lds
s_waitcnt lgkmcnt(6)
v_mfma_f32_32x32x16_bf16 v[64:79], v[132:135], v[172:175], v[64:79]
buffer_load_dwordx4 v3, s[4:7], s34 offen offset:1024  lds
s_waitcnt lgkmcnt(3)
v_mfma_f32_32x32x16_bf16 v[64:79], v[136:139], a[8:11], v[64:79]
buffer_load_dwordx4 v4, s[8:11], s35 offen offset:2048  lds
s_waitcnt lgkmcnt(0)
v_mfma_f32_32x32x16_bf16 v[64:79], v[140:143], a[12:15], v[64:79]
buffer_load_dwordx4 v5, s[8:11], s35 offen offset:3072  lds
s_cmp_eq_u32 s45, 1
s_cbranch_scc1 L_res1
L_resb1:
s_waitcnt vmcnt(12)
s_barrier
v_mfma_f32_16x16x32_bf16 v[24:27], v[16:19], v[128:131], v[24:27]
ds_read_b64_tr_b16 v[96:97], v10 offset:34816
ds_read_b64_tr_b16 v[98:99], v10 offset:35328
v_mfma_f32_4x4x4_16b_bf16 v[224:227], v[168:169], v[168:169], v[224:227]
ds_read_b128 v[176:179], v6 offset:32768
v_mfma_f32_16x16x32_bf16 v[20:23], v[16:19], v[168:171], v[20:23]
ds_read_b64_tr_b16 v[100:101], v11 offset:34816
ds_read_b64_tr_b16 v[102:103], v11 offset:35328
v_mfma_f32_4x4x4_16b_bf16 v[224:227], v[170:171], v[170:171], v[224:227]
ds_read_b128 v[180:183], v7 offset:32768
v_mfma_f32_16x16x32_bf16 v[24:27], v[16:19], v[136:139], v[24:27]
ds_read_b64_tr_b16 v[104:105], v12 offset:34816
ds_read_b64_tr_b16 v[106:107], v12 offset:35328
v_mfma_f32_4x4x4_16b_bf16 v[224:227], v[172:173], v[172:173], v[224:227]
ds_read_b128 a[16:19], v8 offset:32768
v_mfma_f32_16x16x32_bf16 v[20:23], v[16:19], v[172:175], v[20:23]
ds_read_b64_tr_b16 v[108:109], v13 offset:34816
ds_read_b64_tr_b16 v[110:111], v13 offset:35328
v_mfma_f32_4x4x4_16b_bf16 v[224:227], v[174:175], v[174:175], v[224:227]
ds_read_b128 a[20:23], v9 offset:32768
s_waitcnt lgkmcnt(9)
v_mfma_f32_32x32x16_bf16 v[64:79], v[96:99], v[176:179], v[64:79]
s_add_u32 m0, s36, 16384
s_add_u32 s34, s34, 128
s_and_b32 s34, s34, 1023
s_mul_i32 s35, s34, 1536
buffer_load_dwordx4 v2, s[4:7], s34 offen  lds
buffer_load_dwordx4 v3, s[4:7], s34 offen offset:1024  lds
s_waitcnt lgkmcnt(6)
v_mfma_f32_32x32x16_bf16 v[64:79], v[100:103], v[180:183], v[64:79]
buffer_load_dwordx4 v4, s[8:11], s35 offen offset:2048  lds
s_waitcnt lgkmcnt(3)
v_mfma_f32_32x32x16_bf16 v[64:79], v[104:107], a[16:19], v[64:79]
buffer_load_dwordx4 v5, s[8:11], s35 offen offset:3072  lds
s_cmp_eq_u32 s45, 2
s_cbranch_scc1 L_res2
L_resb2:
s_waitcnt vmcnt(12) lgkmcnt(0)
s_barrier
v_mfma_f32_32x32x16_bf16 v[64:79], v[108:111], a[20:23], v[64:79]
ds_read_b64_tr_b16 v[128:129], v10 offset:51200
ds_read_b64_tr_b16 v[130:131], v10 offset:51712
ds_read_b128 v[184:187], v6 offset:49152
ds_read_b64_tr_b16 v[132:133], v11 offset:51200
s_add_u32 m0, s36, 32768
v_mfma_f32_16x16x32_bf16 v[24:27], v[16:19], v[96:99], v[24:27]
ds_read_b64_tr_b16 v[134:135], v11 offset:51712
v_mfma_f32_4x4x4_16b_bf16 v[224:227], v[176:177], v[176:177], v[224:227]
ds_read_b128 v[188:191], v7 offset:49152
v_mfma_f32_16x16x32_bf16 v[20:23], v[16:19], v[176:179], v[20:23]
ds_read_b64_tr_b16 v[136:137], v12 offset:51200
v_mfma_f32_4x4x4_16b_bf16 v[224:227], v[178:179], v[178:179], v[224:227]
ds_read_b64_tr_b16 v[138:139], v12 offset:51712
v_mfma_f32_16x16x32_bf16 v[24:27], v[16:19], v[104:107], v[24:27]
ds_read_b128 a[24:27], v8 offset:49152
v_mfma_f32_4x4x4_16b_bf16 v[224:227], v[180:181], v[180:181], v[224:227]
ds_read_b64_tr_b16 v[140:141], v13 offset:51200
v_mfma_f32_16x16x32_bf16 v[20:23], v[16:19], v[180:183], v[20:23]
ds_read_b64_tr_b16 v[142:143], v13 offset:51712
v_mfma_f32_4x4x4_16b_bf16 v[224:227], v[182:183], v[182:183], v[224:227]
ds_read_b128 a[28:31], v9 offset:49152
s_waitcnt lgkmcnt(9)
v_mfma_f32_32x32x16_bf16 v[64:79], v[128:131], v[184:187], v[64:79]
s_add_u32 s34, s34, 128
s_and_b32 s34, s34, 1023
s_mul_i32 s35, s34, 1536
buffer_load_dwordx4 v2, s[4:7], s34 offen  lds
buffer_load_dwordx4 v3, s[4:7], s34 offen offset:1024  lds
s_waitcnt lgkmcnt(6)
v_mfma_f32_32x32x16_bf16 v[64:79], v[132:135], v[188:191], v[64:79]
buffer_load_dwordx4 v4, s[8:11], s35 offen offset:2048  lds
s_waitcnt lgkmcnt(3)
v_mfma_f32_32x32x16_bf16 v[64:79], v[136:139], a[24:27], v[64:79]
buffer_load_dwordx4 v5, s[8:11], s35 offen offset:3072  lds
s_cmp_eq_u32 s45, 3
s_cbranch_scc1 L_res3
L_resb3:
s_waitcnt vmcnt(8) lgkmcnt(0)
s_barrier
v_mfma_f32_32x32x16_bf16 v[64:79], v[140:143], a[28:31], v[64:79]
ds_read_b64_tr_b16 v[96:97], v10 offset:2048
ds_read_b64_tr_b16 v[98:99], v10 offset:2560
ds_read_b128 v[192:195], v6 offset:0
ds_read_b64_tr_b16 v[100:101], v11 offset:2048
s_add_u32 m0, s36, 49152
v_mfma_f32_16x16x32_bf16 v[24:27], v[16:19], v[128:131], v[24:27]
ds_read_b64_tr_b16 v[102:103], v11 offset:2560
v_mfma_f32_4x4x4_16b_bf16 v[224:227], v[184:185], v[184:185], v[224:227]
ds_read_b128 v[196:199], v7 offset:0
v_mfma_f32_16x16x32_bf16 v[20:23], v[16:19], v[184:187], v[20:23]
ds_read_b64_tr_b16 v[104:105], v12 offset:2048
v_mfma_f32_4x4x4_16b_bf16 v[224:227], v[186:187], v[186:187], v[224:227]
ds_read_b64_tr_b16 v[106:107], v12 offset:2560
v_mfma_f32_16x16x32_bf16 v[24:27], v[16:19], v[136:139], v[24:27]
ds_read_b128 a[32:35], v8 offset:0
v_mfma_f32_4x4x4_16b_bf16 v[224:227], v[188:189], v[188:189], v[224:227]
ds_read_b64_tr_b16 v[108:109], v13 offset:2048
v_mfma_f32_16x16x32_bf16 v[20:23], v[16:19], v[188:191], v[20:23]
ds_read_b64_tr_b16 v[110:111], v13 offset:2560
v_mfma_f32_4x4x4_16b_bf16 v[224:227], v[190:191], v[190:191], v[224:227]
ds_read_b128 a[36:39], v9 offset:0
s_waitcnt lgkmcnt(9)
v_mfma_f32_32x32x16_bf16 v[64:79], v[96:99], v[192:195], v[64:79]
s_add_u32 s34, s34, 128
s_and_b32 s34, s34, 1023
s_mul_i32 s35, s34, 1536
buffer_load_dwordx4 v2, s[4:7], s34 offen  lds
buffer_load_dwordx4 v3, s[4:7], s34 offen offset:1024  lds
s_waitcnt lgkmcnt(6)
v_mfma_f32_32x32x16_bf16 v[64:79], v[100:103], v[196:199], v[64:79]
buffer_load_dwordx4 v4, s[8:11], s35 offen offset:2048  lds
s_waitcnt lgkmcnt(3)
v_mfma_f32_32x32x16_bf16 v[64:79], v[104:107], a[32:35], v[64:79]
buffer_load_dwordx4 v5, s[8:11], s35 offen offset:3072  lds
s_cmp_eq_u32 s45, 4
s_cbranch_scc1 L_res4
L_resb4:
s_waitcnt vmcnt(8) lgkmcnt(0)
s_barrier
v_mfma_f32_32x32x16_bf16 v[64:79], v[108:111], a[36:39], v[64:79]
ds_read_b64_tr_b16 v[128:129], v10 offset:18432
ds_read_b64_tr_b16 v[130:131], v10 offset:18944
ds_read_b128 v[200:203], v6 offset:16384
ds_read_b64_tr_b16 v[132:133], v11 offset:18432
s_add_u32 m0, s36, 0
v_mfma_f32_16x16x32_bf16 v[24:27], v[16:19], v[96:99], v[24:27]
ds_read_b64_tr_b16 v[134:135], v11 offset:18944
v_mfma_f32_4x4x4_16b_bf16 v[224:227], v[192:193], v[192:193], v[224:227]
ds_read_b128 v[204:207], v7 offset:16384
v_mfma_f32_16x16x32_bf16 v[20:23], v[16:19], v[192:195], v[20:23]
ds_read_b64_tr_b16 v[136:137], v12 offset:18432
v_mfma_f32_4x4x4_16b_bf16 v[224:227], v[194:195], v[194:195], v[224:227]
ds_read_b64_tr_b16 v[138:139], v12 offset:18944
v_mfma_f32_16x16x32_bf16 v[24:27], v[16:19], v[104:107], v[24:27]
ds_read_b128 a[40:43], v8 offset:16384
v_mfma_f32_4x4x4_16b_bf16 v[224:227], v[196:197], v[196:197], v[224:227]
ds_read_b64_tr_b16 v[140:141], v13 offset:18432
v_mfma_f32_16x16x32_bf16 v[20:23], v[16:19], v[196:199], v[20:23]
ds_read_b64_tr_b16 v[142:143], v13 offset:18944
v_mfma_f32_4x4x4_16b_bf16 v[224:227], v[198:199], v[198:199], v[224:227]
ds_read_b128 a[44:47], v9 offset:16384
s_waitcnt lgkmcnt(9)
v_mfma_f32_32x32x16_bf16 v[64:79], v[128:131], v[200:203], v[64:79]
v_add_u32 v2, 3072, v4
v_add_u32 v3, 3072, v5
v_add_u32 v4, 197632, v4
v_add_u32 v5, 197632, v5
s_add_u32 s34, s34, 128
s_and_b32 s34, s34, 1023
s_mul_i32 s35, s34, 1536
buffer_load_dwordx4 v2, s[8:11], s35 offen  lds
buffer_load_dwordx4 v3, s[8:11], s35 offen offset:1024  lds
s_waitcnt lgkmcnt(6)
v_mfma_f32_32x32x16_bf16 v[64:79], v[132:135], v[204:207], v[64:79]
buffer_load_dwordx4 v4, s[8:11], s35 offen offset:2048  lds
s_waitcnt lgkmcnt(3)
v_mfma_f32_32x32x16_bf16 v[64:79], v[136:139], a[40:43], v[64:79]
buffer_load_dwordx4 v5, s[8:11], s35 offen offset:3072  lds
s_cmp_eq_u32 s45, 5
s_cbranch_scc1 L_res5
L_resb5:
s_waitcnt vmcnt(8) lgkmcnt(0)
s_barrier
v_mfma_f32_32x32x16_bf16 v[64:79], v[140:143], a[44:47], v[64:79]
ds_read_b64_tr_b16 v[96:97], v10 offset:34816
ds_read_b64_tr_b16 v[98:99], v10 offset:35328
ds_read_b128 v[208:211], v6 offset:32768
ds_read_b64_tr_b16 v[100:101], v11 offset:34816
s_add_u32 m0, s36, 16384
v_mfma_f32_16x16x32_bf16 v[24:27], v[16:19], v[128:131], v[24:27]
ds_read_b64_tr_b16 v[102:103], v11 offset:35328
v_mfma_f32_4x4x4_16b_bf16 v[224:227], v[200:201], v[200:201], v[224:227]
ds_read_b128 v[212:215], v7 offset:32768
v_mfma_f32_16x16x32_bf16 v[20:23], v[16:19], v[200:203], v[20:23]
ds_read_b64_tr_b16 v[104:105], v12 offset:34816
v_mfma_f32_4x4x4_16b_bf16 v[224:227], v[202:203], v[202:203], v[224:227]
ds_read_b64_tr_b16 v[106:107], v12 offset:35328
v_mfma_f32_16x16x32_bf16 v[24:27], v[16:19], v[136:139], v[24:27]
ds_read_b128 a[48:51], v8 offset:32768
v_mfma_f32_4x4x4_16b_bf16 v[224:227], v[204:205], v[204:205], v[224:227]
ds_read_b64_tr_b16 v[108:109], v13 offset:34816
v_mfma_f32_16x16x32_bf16 v[20:23], v[16:19], v[204:207], v[20:23]
ds_read_b64_tr_b16 v[110:111], v13 offset:35328
v_mfma_f32_4x4x4_16b_bf16 v[224:227], v[206:207], v[206:207], v[224:227]
ds_read_b128 a[52:55], v9 offset:32768
s_waitcnt lgkmcnt(9)
v_mfma_f32_32x32x16_bf16 v[64:79], v[96:99], v[208:211], v[64:79]
s_add_u32 s34, s34, 256
s_and_b32 s34, s34, 1023
s_mul_i32 s35, s34, 1536
buffer_load_dwordx4 v2, s[8:11], s35 offen  lds
buffer_load_dwordx4 v3, s[8:11], s35 offen offset:1024  lds
s_mov_b64 exec, 1
global_load_dwordx2 v[34:35], v1, s[18:19] sc1
s_mov_b64 exec, -1
s_waitcnt lgkmcnt(6)
v_mfma_f32_32x32x16_bf16 v[64:79], v[100:103], v[212:215], v[64:79]
buffer_load_dwordx4 v4, s[8:11], s35 offen offset:2048  lds
s_waitcnt lgkmcnt(3)
v_mfma_f32_32x32x16_bf16 v[64:79], v[104:107], a[48:51], v[64:79]
buffer_load_dwordx4 v5, s[8:11], s35 offen offset:3072  lds
s_cmp_eq_u32 s45, 6
s_cbranch_scc1 L_res6
L_resb6:
s_waitcnt vmcnt(9) lgkmcnt(0)
s_barrier
v_mfma_f32_32x32x16_bf16 v[64:79], v[108:111], a[52:55], v[64:79]
ds_read_b64_tr_b16 v[128:129], v10 offset:51200
ds_read_b64_tr_b16 v[130:131], v10 offset:51712
ds_read_b128 v[216:219], v6 offset:49152
ds_read_b64_tr_b16 v[136:137], v12 offset:51200
v_mfma_f32_16x16x32_bf16 v[24:27], v[16:19], v[96:99], v[24:27]
ds_read_b64_tr_b16 v[138:139], v12 offset:51712
v_mfma_f32_4x4x4_16b_bf16 v[224:227], v[208:209], v[208:209], v[224:227]
ds_read_b128 v[220:223], v7 offset:49152
v_mfma_f32_16x16x32_bf16 v[20:23], v[16:19], v[208:211], v[20:23]
ds_read_b64_tr_b16 v[132:133], v11 offset:51200
v_mfma_f32_4x4x4_16b_bf16 v[224:227], v[210:211], v[210:211], v[224:227]
ds_read_b64_tr_b16 v[134:135], v11 offset:51712
v_mfma_f32_16x16x32_bf16 v[24:27], v[16:19], v[104:107], v[24:27]
ds_read_b128 a[56:59], v8 offset:49152
v_mfma_f32_4x4x4_16b_bf16 v[224:227], v[212:213], v[212:213], v[224:227]
ds_read_b64_tr_b16 v[140:141], v13 offset:51200
v_mfma_f32_16x16x32_bf16 v[20:23], v[16:19], v[212:215], v[20:23]
ds_read_b64_tr_b16 v[142:143], v13 offset:51712
v_mfma_f32_4x4x4_16b_bf16 v[224:227], v[214:215], v[214:215], v[224:227]
ds_read_b128 a[60:63], v9 offset:49152
s_waitcnt lgkmcnt(10)
v_mfma_f32_16x16x32_bf16 v[24:27], v[16:19], v[128:131], v[24:27]
s_add_u32 m0, s36, 32768
s_waitcnt lgkmcnt(9)
v_mfma_f32_4x4x4_16b_bf16 v[224:227], v[216:217], v[216:217], v[224:227]
s_add_u32 s34, s34, 256
v_mfma_f32_16x16x32_bf16 v[20:23], v[16:19], v[216:219], v[20:23]
s_and_b32 s34, s34, 1023
v_mfma_f32_4x4x4_16b_bf16 v[224:227], v[218:219], v[218:219], v[224:227]
s_mul_i32 s35, s34, 1536
s_waitcnt lgkmcnt(7)
v_mfma_f32_16x16x32_bf16 v[24:27], v[16:19], v[136:139], v[24:27]
buffer_load_dwordx4 v2, s[8:11], s35 offen  lds
s_waitcnt lgkmcnt(6)
v_mfma_f32_4x4x4_16b_bf16 v[224:227], v[220:221], v[220:221], v[224:227]
buffer_load_dwordx4 v3, s[8:11], s35 offen offset:1024  lds
v_mfma_f32_16x16x32_bf16 v[20:23], v[16:19], v[220:223], v[20:23]
buffer_load_dwordx4 v4, s[8:11], s35 offen offset:2048  lds
v_mfma_f32_4x4x4_16b_bf16 v[224:227], v[222:223], v[222:223], v[224:227]
buffer_load_dwordx4 v5, s[8:11], s35 offen offset:3072  lds
v_mfma_f32_32x32x16_bf16 v[64:79], v[128:131], v[216:219], v[64:79]
v_xor_b32 v48, 1024, v33
v_xor_b32 v49, 512, v33
s_nop 0
v_cndmask_b32 v224, v224, v225, s[82:83]
v_cndmask_b32 v226, v226, v227, s[82:83]
v_cndmask_b32 v224, v224, v226, s[84:85]
s_waitcnt lgkmcnt(4)
v_mfma_f32_32x32x16_bf16 v[64:79], v[132:135], v[220:223], v[64:79]
s_cmp_eq_u32 s45, 7
s_cbranch_scc1 L_res7
L_resb7:
v_permlane32_swap_b32 v20, v224
v_add_f32 v20, v20, v224
ds_write2_b32 v33, v20, v24 offset0:0 offset1:1
s_waitcnt lgkmcnt(4)
v_mfma_f32_32x32x16_bf16 v[64:79], v[136:139], a[56:59], v[64:79]
s_waitcnt vmcnt(9) lgkmcnt(0)
s_barrier
ds_read_b32 v48, v48
ds_read_b32 v49, v49 offset:4
v_mfma_f32_32x32x16_bf16 v[64:79], v[140:143], a[60:63], v[64:79]
ds_read_b64_tr_b16 v[96:97], v10 offset:0
ds_read_b64_tr_b16 v[98:99], v10 offset:512
ds_read_b64_tr_b16 v[100:101], v11 offset:0
ds_read_b64_tr_b16 v[102:103], v11 offset:512
ds_read_b64_tr_b16 v[104:105], v12 offset:0
ds_read_b64_tr_b16 v[106:107], v12 offset:512
s_add_u32 m0, s36, 49152
s_add_u32 s34, s34, 256
s_and_b32 s34, s34, 1023
s_mul_i32 s35, s34, 1536
buffer_load_dwordx4 v2, s[8:11], s35 offen  lds
buffer_load_dwordx4 v3, s[8:11], s35 offen offset:1024  lds
buffer_load_dwordx4 v4, s[8:11], s35 offen offset:2048  lds
buffer_load_dwordx4 v5, s[8:11], s35 offen offset:3072  lds
s_waitcnt lgkmcnt(7)
v_add_f32 v20, v20, v48
s_waitcnt lgkmcnt(6)
v_add_f32 v49, v49, v24
v_mov_b32 v21, v20
v_cvt_pk_bf16_f32 v30, v49, v49
v_and_b32 v50, 0xffff0000, v30
v_permlane32_swap_b32 v20, v21
s_waitcnt lgkmcnt(4)
v_mfma_f32_32x32x16_bf16 v[80:95], v[160:163], v[96:99], 0
v_mul_f32 v20, 0xbb000000, v20
v_mul_f32 v21, 0x3b000000, v21
v_cvt_pk_bf16_f32 v22, v20, v20
v_fma_f32 v21, -v20, v20, v21
v_and_b32 v22, 0xffff0000, v22
v_max_f32 v21, 0, v21
v_sub_f32 v20, v20, v22
s_waitcnt lgkmcnt(2)
v_mfma_f32_32x32x16_bf16 v[80:95], v[164:167], v[100:103], v[80:95]
v_add_f32 v21, 0x3727c5ac, v21
v_cvt_pk_bf16_f32 v28, v22, v20
v_cvt_pk_bf16_f32 v29, v22, v20
v_sub_f32 v50, v49, v50
v_cvt_pk_bf16_f32 v31, v50, v50
v_rsq_f32 v32, v21
ds_read_b64_tr_b16 v[108:109], v13 offset:0
ds_read_b64_tr_b16 v[110:111], v13 offset:512
v_mfma_f32_32x32x8_bf16 v[64:79], v[30:31], v[28:29], v[64:79]
ds_read_b64_tr_b16 v[112:113], v10 offset:2048
ds_read_b64_tr_b16 v[114:115], v10 offset:2560
ds_read_b64_tr_b16 v[116:117], v11 offset:2048
ds_read_b64_tr_b16 v[118:119], v11 offset:2560
s_waitcnt lgkmcnt(6)
v_mfma_f32_32x32x16_bf16 v[80:95], a[0:3], v[104:107], v[80:95]
ds_read_b64_tr_b16 v[120:121], v12 offset:2048
ds_read_b64_tr_b16 v[122:123], v12 offset:2560
ds_read_b64_tr_b16 v[124:125], v13 offset:2048
ds_read_b64_tr_b16 v[126:127], v13 offset:2560
s_waitcnt lgkmcnt(8)
v_mfma_f32_32x32x16_bf16 v[80:95], a[4:7], v[108:111], v[80:95]
v_mul_f32 v64, v32, v64
v_mul_f32 v65, v32, v65
v_mul_f32 v66, v32, v66
v_mul_f32 v67, v32, v67
v_mul_f32 v68, v32, v68
v_mul_f32 v69, v32, v69
v_mul_f32 v70, v32, v70
v_mul_f32 v71, v32, v71
v_cvt_pk_bf16_f32 v40, v64, v65
s_waitcnt lgkmcnt(6)
v_mfma_f32_32x32x16_bf16 v[80:95], v[168:171], v[112:115], v[80:95]
v_cvt_pk_bf16_f32 v41, v66, v67
v_cvt_pk_bf16_f32 v42, v68, v69
v_cvt_pk_bf16_f32 v43, v70, v71
buffer_store_dwordx4 v[40:43], v1, s[12:15], s46 offen sc1
s_add_u32 s46, s46, 0x10000
v_mul_f32 v72, v32, v72
v_mul_f32 v73, v32, v73
v_mul_f32 v74, v32, v74
v_mul_f32 v75, v32, v75
s_waitcnt lgkmcnt(4)
v_mfma_f32_32x32x16_bf16 v[80:95], v[172:175], v[116:119], v[80:95]
v_mul_f32 v76, v32, v76
v_mul_f32 v77, v32, v77
v_mul_f32 v78, v32, v78
v_mul_f32 v79, v32, v79
v_cvt_pk_bf16_f32 v44, v72, v73
v_cvt_pk_bf16_f32 v45, v74, v75
v_cvt_pk_bf16_f32 v46, v76, v77
v_cvt_pk_bf16_f32 v47, v78, v79
buffer_store_dwordx4 v[44:47], v1, s[12:15], s46 offen sc1
s_waitcnt vmcnt(10) lgkmcnt(0)
s_barrier
v_mfma_f32_32x32x16_bf16 v[80:95], a[8:11], v[120:123], v[80:95]
ds_read_b64_tr_b16 v[128:129], v10 offset:16384
ds_read_b64_tr_b16 v[130:131], v10 offset:16896
ds_read_b64_tr_b16 v[132:133], v11 offset:16384
s_add_u32 m0, s36, 0
v_subrev_u32 v4, 2048, v4
v_mfma_f32_32x32x16_bf16 v[80:95], a[12:15], v[124:127], v[80:95]
ds_read_b64_tr_b16 v[134:135], v11 offset:16896
ds_read_b64_tr_b16 v[136:137], v12 offset:16384
ds_read_b64_tr_b16 v[138:139], v12 offset:16896
v_subrev_u32 v5, 2048, v5
v_subrev_u32 v2, 2048, v2
v_mfma_f32_16x16x32_bf16 v[24:27], v[16:19], v[96:99], 0
ds_read_b64_tr_b16 v[140:141], v13 offset:16384
v_mfma_f32_16x16x32_bf16 v[24:27], v[16:19], v[104:107], v[24:27]
ds_read_b64_tr_b16 v[142:143], v13 offset:16896
v_mfma_f32_16x16x32_bf16 v[24:27], v[16:19], v[112:115], v[24:27]
v_mfma_f32_16x16x32_bf16 v[24:27], v[16:19], v[120:123], v[24:27]
s_waitcnt lgkmcnt(6)
v_mfma_f32_32x32x16_bf16 v[80:95], v[176:179], v[128:131], v[80:95]
ds_read_b64_tr_b16 v[144:145], v10 offset:18432
ds_read_b64_tr_b16 v[146:147], v10 offset:18944
v_subrev_u32 v3, 2048, v3
s_add_u32 s34, s34, 256
s_and_b32 s34, s34, 1023
s_mul_i32 s35, s34, 1536
buffer_load_dwordx4 v2, s[8:11], s35 offen  lds
ds_write_b128 v252, v[40:43] offset:0
s_waitcnt lgkmcnt(7)
v_mfma_f32_32x32x16_bf16 v[80:95], v[180:183], v[132:135], v[80:95]
ds_read_b64_tr_b16 v[148:149], v11 offset:18432
ds_read_b64_tr_b16 v[150:151], v11 offset:18944
buffer_load_dwordx4 v3, s[8:11], s35 offen offset:1024  lds
ds_write_b32 v254, v32
s_waitcnt lgkmcnt(8)
v_mfma_f32_32x32x16_bf16 v[80:95], a[16:19], v[136:139], v[80:95]
ds_read_b64_tr_b16 v[152:153], v12 offset:18432
ds_read_b64_tr_b16 v[154:155], v12 offset:18944
buffer_load_dwordx4 v4, s[8:11], s35 offen offset:2048  lds
ds_write_b128 v252, v[44:47] offset:2048
s_waitcnt lgkmcnt(9)
v_mfma_f32_32x32x16_bf16 v[80:95], a[20:23], v[140:143], v[80:95]
ds_read_b64_tr_b16 v[156:157], v13 offset:18432
ds_read_b64_tr_b16 v[158:159], v13 offset:18944
buffer_load_dwordx4 v5, s[8:11], s35 offen offset:3072  lds
s_waitcnt lgkmcnt(9)
v_mfma_f32_32x32x16_bf16 v[80:95], v[184:187], v[144:147], v[80:95]
s_waitcnt lgkmcnt(6)
v_mfma_f32_32x32x16_bf16 v[80:95], v[188:191], v[148:151], v[80:95]
s_waitcnt vmcnt(10) lgkmcnt(0)
s_barrier
v_mfma_f32_32x32x16_bf16 v[80:95], a[24:27], v[152:155], v[80:95]
ds_read_b64_tr_b16 v[96:97], v10 offset:32768
ds_read_b64_tr_b16 v[98:99], v10 offset:33280
ds_read_b64_tr_b16 v[100:101], v11 offset:32768
s_add_u32 m0, s36, 16384
s_add_u32 s34, s34, 256
v_mfma_f32_32x32x16_bf16 v[80:95], a[28:31], v[156:159], v[80:95]
ds_read_b64_tr_b16 v[102:103], v11 offset:33280
ds_read_b64_tr_b16 v[104:105], v12 offset:32768
ds_read_b64_tr_b16 v[106:107], v12 offset:33280
s_and_b32 s34, s34, 1023
s_mul_i32 s35, s34, 1536
v_mfma_f32_16x16x32_bf16 v[24:27], v[16:19], v[128:131], v[24:27]
ds_read_b64_tr_b16 v[108:109], v13 offset:32768
v_mfma_f32_16x16x32_bf16 v[24:27], v[16:19], v[136:139], v[24:27]
ds_read_b64_tr_b16 v[110:111], v13 offset:33280
v_mfma_f32_16x16x32_bf16 v[24:27], v[16:19], v[144:147], v[24:27]
ds_read_b128 v[224:227], v255 offset:0
ds_read_b128 v[228:231], v255 offset:32
v_mfma_f32_16x16x32_bf16 v[24:27], v[16:19], v[152:155], v[24:27]
ds_read_b128 v[48:51], v255 offset:64
ds_read_b128 v[52:55], v255 offset:96
s_waitcnt lgkmcnt(10)
v_mfma_f32_32x32x16_bf16 v[80:95], v[192:195], v[96:99], v[80:95]
ds_read_b64_tr_b16 v[112:113], v10 offset:34816
ds_read_b64_tr_b16 v[114:115], v10 offset:35328
buffer_load_dwordx4 v2, s[8:11], s35 offen  lds
s_waitcnt lgkmcnt(10)
v_mfma_f32_32x32x16_bf16 v[80:95], v[196:199], v[100:103], v[80:95]
ds_read_b64_tr_b16 v[116:117], v11 offset:34816
ds_read_b64_tr_b16 v[118:119], v11 offset:35328
buffer_load_dwordx4 v3, s[8:11], s35 offen offset:1024  lds
s_waitcnt lgkmcnt(10)
v_mfma_f32_32x32x16_bf16 v[80:95], a[32:35], v[104:107], v[80:95]
ds_read_b64_tr_b16 v[120:121], v12 offset:34816
ds_read_b64_tr_b16 v[122:123], v12 offset:35328
buffer_load_dwordx4 v4, s[8:11], s35 offen offset:2048  lds
s_waitcnt lgkmcnt(10)
v_mfma_f32_32x32x16_bf16 v[80:95], a[36:39], v[108:111], v[80:95]
ds_read_b64_tr_b16 v[124:125], v13 offset:34816
ds_read_b64_tr_b16 v[126:127], v13 offset:35328
buffer_load_dwordx4 v5, s[8:11], s35 offen offset:3072  lds
s_waitcnt lgkmcnt(6)
v_mfma_f32_32x32x16_bf16 v[80:95], v[200:203], v[112:115], v[80:95]
v_readfirstlane_b32 s83, v35
v_readfirstlane_b32 s82, v34
s_cmp_lg_u32 s83, 0
s_cbranch_scc0 L_spin_non
L_ok_non:
s_waitcnt lgkmcnt(4)
v_mfma_f32_32x32x16_bf16 v[80:95], v[204:207], v[116:119], v[80:95]
s_waitcnt vmcnt(10) lgkmcnt(0)
s_barrier
v_mfma_f32_32x32x16_bf16 v[80:95], a[40:43], v[120:123], v[80:95]
ds_read_b64_tr_b16 v[128:129], v10 offset:49152
ds_read_b64_tr_b16 v[130:131], v10 offset:49664
ds_read_b64_tr_b16 v[136:137], v12 offset:49152
s_add_u32 m0, s36, 32768
s_add_u32 s34, s34, 256
v_mfma_f32_32x32x16_bf16 v[80:95], a[44:47], v[124:127], v[80:95]
ds_read_b64_tr_b16 v[138:139], v12 offset:49664
ds_read_b64_tr_b16 v[144:145], v10 offset:51200
ds_read_b64_tr_b16 v[146:147], v10 offset:51712
s_and_b32 s34, s34, 1023
s_mul_i32 s35, s34, 1536
v_mfma_f32_16x16x32_bf16 v[24:27], v[16:19], v[96:99], v[24:27]
ds_read_b64_tr_b16 v[152:153], v12 offset:51200
v_mfma_f32_16x16x32_bf16 v[24:27], v[16:19], v[104:107], v[24:27]
ds_read_b64_tr_b16 v[154:155], v12 offset:51712
v_mfma_f32_16x16x32_bf16 v[24:27], v[16:19], v[112:115], v[24:27]
v_mfma_f32_16x16x32_bf16 v[24:27], v[16:19], v[120:123], v[24:27]
s_waitcnt lgkmcnt(6)
v_mfma_f32_16x16x32_bf16 v[24:27], v[16:19], v[128:131], v[24:27]
ds_read_b64_tr_b16 v[132:133], v11 offset:49152
ds_read_b64_tr_b16 v[134:135], v11 offset:49664
s_waitcnt lgkmcnt(6)
v_mfma_f32_16x16x32_bf16 v[24:27], v[16:19], v[136:139], v[24:27]
ds_read_b64_tr_b16 v[140:141], v13 offset:49152
ds_read_b64_tr_b16 v[142:143], v13 offset:49664
s_waitcnt lgkmcnt(6)
v_mfma_f32_16x16x32_bf16 v[24:27], v[16:19], v[144:147], v[24:27]
ds_read_b64_tr_b16 v[148:149], v11 offset:51200
ds_read_b64_tr_b16 v[150:151], v11 offset:51712
s_waitcnt vmcnt(8)
s_barrier
buffer_store_dwordx2 v[34:35], v36, s[12:15], 0 offen offset:0 sc1
s_waitcnt lgkmcnt(6)
v_mfma_f32_16x16x32_bf16 v[24:27], v[16:19], v[152:155], v[24:27]
ds_read_b64_tr_b16 v[156:157], v13 offset:51200
ds_read_b64_tr_b16 v[158:159], v13 offset:51712
v_mfma_f32_32x32x16_bf16 v[80:95], v[208:211], v[128:131], v[80:95]
buffer_load_dwordx4 v2, s[8:11], s35 offen  lds
v_mfma_f32_32x32x16_bf16 v[80:95], a[48:51], v[136:139], v[80:95]
buffer_load_dwordx4 v3, s[8:11], s35 offen offset:1024  lds
v_mfma_f32_32x32x16_bf16 v[80:95], v[216:219], v[144:147], v[80:95]
s_nop 0
ds_write_b32 v33, v24 offset:4
v_xor_b32 v20, 512, v33
buffer_load_dwordx4 v4, s[8:11], s35 offen offset:2048  lds
v_mfma_f32_32x32x16_bf16 v[80:95], a[56:59], v[152:155], v[80:95]
buffer_load_dwordx4 v5, s[8:11], s35 offen offset:3072  lds
s_waitcnt lgkmcnt(7)
v_mfma_f32_32x32x16_bf16 v[80:95], v[212:215], v[132:135], v[80:95]
s_waitcnt vmcnt(9) lgkmcnt(0)
s_barrier
ds_read_b32 v20, v20 offset:4
v_mfma_f32_32x32x16_bf16 v[80:95], a[52:55], v[140:143], v[80:95]
ds_read_b64_tr_b16 v[96:97], v10 offset:0
ds_read_b64_tr_b16 v[98:99], v10 offset:512
ds_read_b64_tr_b16 v[100:101], v11 offset:0
ds_read_b64_tr_b16 v[102:103], v11 offset:512
v_mfma_f32_32x32x16_bf16 v[80:95], v[220:223], v[148:151], v[80:95]
ds_read_b64_tr_b16 v[104:105], v12 offset:0
ds_read_b64_tr_b16 v[106:107], v12 offset:512
s_add_u32 m0, s36, 49152
s_add_u32 s34, s34, 256
s_and_b32 s34, s34, 1023
s_mul_i32 s35, s34, 1536
buffer_load_dwordx4 v2, s[8:11], s35 offen  lds
v_mfma_f32_32x32x16_bf16 v[80:95], a[60:63], v[156:159], v[80:95]
s_waitcnt lgkmcnt(6)
v_add_f32 v20, v20, v24
v_cvt_pk_bf16_f32 v30, v20, v20
v_and_b32 v21, 0xffff0000, v30
v_sub_f32 v21, v20, v21
v_cvt_pk_bf16_f32 v31, v21, v21
buffer_load_dwordx4 v3, s[8:11], s35 offen offset:1024  lds
s_nop 0
v_mfma_f32_32x32x8_bf16 v[80:95], v[28:29], v[30:31], v[80:95]
ds_read_b64_tr_b16 v[108:109], v13 offset:0
ds_read_b64_tr_b16 v[110:111], v13 offset:512
ds_read_b64_tr_b16 v[112:113], v10 offset:2048
ds_read_b64_tr_b16 v[114:115], v10 offset:2560
buffer_load_dwordx4 v4, s[8:11], s35 offen offset:2048  lds
s_waitcnt lgkmcnt(8)
v_mfma_f32_32x32x16_bf16 v[64:79], v[96:99], v[160:163], 0
ds_read_b64_tr_b16 v[116:117], v11 offset:2048
ds_read_b64_tr_b16 v[118:119], v11 offset:2560
ds_read_b64_tr_b16 v[120:121], v12 offset:2048
ds_read_b64_tr_b16 v[122:123], v12 offset:2560
buffer_load_dwordx4 v5, s[8:11], s35 offen offset:3072  lds
s_waitcnt lgkmcnt(10)
v_mfma_f32_32x32x16_bf16 v[64:79], v[100:103], v[164:167], v[64:79]
ds_read_b64_tr_b16 v[124:125], v13 offset:2048
ds_read_b64_tr_b16 v[126:127], v13 offset:2560
v_mul_f32 v80, v224, v80
v_mul_f32 v81, v225, v81
v_mul_f32 v82, v226, v82
v_mul_f32 v83, v227, v83
s_waitcnt lgkmcnt(10)
v_mfma_f32_32x32x16_bf16 v[64:79], v[104:107], a[0:3], v[64:79]
v_mul_f32 v84, v228, v84
v_mul_f32 v85, v229, v85
v_mul_f32 v86, v230, v86
v_mul_f32 v87, v231, v87
v_cvt_pk_bf16_f32 v40, v80, v81
v_cvt_pk_bf16_f32 v41, v82, v83
s_waitcnt lgkmcnt(8)
v_mfma_f32_32x32x16_bf16 v[64:79], v[108:111], a[4:7], v[64:79]
v_cvt_pk_bf16_f32 v42, v84, v85
v_cvt_pk_bf16_f32 v43, v86, v87
buffer_store_dwordx4 v[40:43], v251, s[12:15], s47 offen offset:0 sc1
v_mul_f32 v88, v48, v88
v_mul_f32 v89, v49, v89
v_mul_f32 v90, v50, v90
s_waitcnt lgkmcnt(6)
v_mfma_f32_32x32x16_bf16 v[64:79], v[112:115], v[168:171], v[64:79]
v_mul_f32 v91, v51, v91
v_mul_f32 v92, v52, v92
v_mul_f32 v93, v53, v93
v_mul_f32 v94, v54, v94
v_mul_f32 v95, v55, v95
s_waitcnt lgkmcnt(4)
v_mfma_f32_32x32x16_bf16 v[64:79], v[116:119], v[172:175], v[64:79]
v_cvt_pk_bf16_f32 v44, v88, v89
v_cvt_pk_bf16_f32 v45, v90, v91
v_cvt_pk_bf16_f32 v46, v92, v93
v_cvt_pk_bf16_f32 v47, v94, v95
buffer_store_dwordx4 v[44:47], v251, s[12:15], s47 offen offset:512 sc1
s_waitcnt vmcnt(11) lgkmcnt(0)
s_barrier
v_mfma_f32_32x32x16_bf16 v[64:79], v[120:123], a[8:11], v[64:79]
ds_read_b64_tr_b16 v[128:129], v10 offset:16384
ds_read_b64_tr_b16 v[130:131], v10 offset:16896
ds_read_b64_tr_b16 v[132:133], v11 offset:16384
s_mov_b32 s8, s16
s_mov_b32 s9, s17
v_mfma_f32_32x32x16_bf16 v[64:79], v[124:127], a[12:15], v[64:79]
ds_read_b64_tr_b16 v[134:135], v11 offset:16896
ds_read_b64_tr_b16 v[136:137], v12 offset:16384
ds_read_b64_tr_b16 v[138:139], v12 offset:16896
s_mov_b32 s10, 0x80000
s_lshl_b32 s35, s28, 17
v_mfma_f32_16x16x32_bf16 v[24:27], v[16:19], v[96:99], 0
ds_read_b64_tr_b16 v[140:141], v13 offset:16384
v_mfma_f32_16x16x32_bf16 v[24:27], v[16:19], v[104:107], v[24:27]
ds_read_b64_tr_b16 v[142:143], v13 offset:16896
v_mfma_f32_16x16x32_bf16 v[24:27], v[16:19], v[112:115], v[24:27]
v_mfma_f32_16x16x32_bf16 v[24:27], v[16:19], v[120:123], v[24:27]
s_waitcnt lgkmcnt(6)
v_mfma_f32_32x32x16_bf16 v[64:79], v[128:131], v[176:179], v[64:79]
ds_read_b64_tr_b16 v[144:145], v10 offset:18432
ds_read_b64_tr_b16 v[146:147], v10 offset:18944
s_add_u32 m0, s36, 0
s_nop 0
buffer_load_dwordx4 v56, s[8:11], s35 offen offset:0 lds
ds_write_b128 v250, v[40:43] offset:0
s_waitcnt lgkmcnt(7)
v_mfma_f32_32x32x16_bf16 v[64:79], v[132:135], v[180:183], v[64:79]
ds_read_b64_tr_b16 v[148:149], v11 offset:18432
ds_read_b64_tr_b16 v[150:151], v11 offset:18944
buffer_load_dwordx4 v57, s[8:11], s35 offen offset:1024 lds
s_waitcnt lgkmcnt(7)
v_mfma_f32_32x32x16_bf16 v[64:79], v[136:139], a[16:19], v[64:79]
ds_read_b64_tr_b16 v[152:153], v12 offset:18432
ds_read_b64_tr_b16 v[154:155], v12 offset:18944
buffer_load_dwordx4 v58, s[8:11], s35 offen offset:2048 lds
ds_write_b128 v250, v[44:47] offset:512
s_waitcnt lgkmcnt(8)
v_mfma_f32_32x32x16_bf16 v[64:79], v[140:143], a[20:23], v[64:79]
ds_read_b64_tr_b16 v[156:157], v13 offset:18432
ds_read_b64_tr_b16 v[158:159], v13 offset:18944
buffer_load_dwordx4 v59, s[8:11], s35 offen offset:3072 lds
s_waitcnt lgkmcnt(8)
v_mfma_f32_32x32x16_bf16 v[64:79], v[144:147], v[184:187], v[64:79]
s_waitcnt lgkmcnt(5)
v_mfma_f32_32x32x16_bf16 v[64:79], v[148:151], v[188:191], v[64:79]
s_waitcnt vmcnt(10) lgkmcnt(0)
s_barrier
v_mfma_f32_32x32x16_bf16 v[64:79], v[152:155], a[24:27], v[64:79]
ds_read_b64_tr_b16 v[96:97], v10 offset:32768
ds_read_b64_tr_b16 v[98:99], v10 offset:33280
ds_read_b64_tr_b16 v[100:101], v11 offset:32768
s_add_u32 m0, s36, 16384
s_add_u32 s35, s35, 0x8000
v_mfma_f32_32x32x16_bf16 v[64:79], v[156:159], a[28:31], v[64:79]
ds_read_b64_tr_b16 v[102:103], v11 offset:33280
ds_read_b64_tr_b16 v[104:105], v12 offset:32768
ds_read_b64_tr_b16 v[106:107], v12 offset:33280
buffer_load_dwordx4 v56, s[8:11], s35 offen offset:0 lds
v_mfma_f32_16x16x32_bf16 v[24:27], v[16:19], v[128:131], v[24:27]
ds_read_b64_tr_b16 v[108:109], v13 offset:32768
v_mfma_f32_16x16x32_bf16 v[24:27], v[16:19], v[136:139], v[24:27]
ds_read_b64_tr_b16 v[110:111], v13 offset:33280
v_mfma_f32_16x16x32_bf16 v[24:27], v[16:19], v[144:147], v[24:27]
v_accvgpr_read_b32 v2, a135
v_mfma_f32_16x16x32_bf16 v[24:27], v[16:19], v[152:155], v[24:27]
s_sub_u32 s4, s22, 4096
s_subb_u32 s5, s23, 0
s_waitcnt lgkmcnt(6)
v_mfma_f32_32x32x16_bf16 v[64:79], v[96:99], v[192:195], v[64:79]
ds_read_b64_tr_b16 v[112:113], v10 offset:34816
ds_read_b64_tr_b16 v[114:115], v10 offset:35328
s_waitcnt lgkmcnt(6)
v_mfma_f32_32x32x16_bf16 v[64:79], v[100:103], v[196:199], v[64:79]
ds_read_b64_tr_b16 v[116:117], v11 offset:34816
ds_read_b64_tr_b16 v[118:119], v11 offset:35328
buffer_load_dwordx4 v57, s[8:11], s35 offen offset:1024 lds
s_waitcnt lgkmcnt(6)
v_mfma_f32_32x32x16_bf16 v[64:79], v[104:107], a[32:35], v[64:79]
ds_read_b64_tr_b16 v[120:121], v12 offset:34816
ds_read_b64_tr_b16 v[122:123], v12 offset:35328
buffer_load_dwordx4 v58, s[8:11], s35 offen offset:2048 lds
s_waitcnt lgkmcnt(6)
v_mfma_f32_32x32x16_bf16 v[64:79], v[108:111], a[36:39], v[64:79]
ds_read_b64_tr_b16 v[124:125], v13 offset:34816
ds_read_b64_tr_b16 v[126:127], v13 offset:35328
buffer_load_dwordx4 v59, s[8:11], s35 offen offset:3072 lds
s_waitcnt lgkmcnt(6)
v_mfma_f32_32x32x16_bf16 v[64:79], v[112:115], v[200:203], v[64:79]
s_mov_b32 s6, 0x1c1000
s_mov_b32 s22, 0x1c0000
s_mov_b32 s23, 0x20000
s_add_u32 s0, s0, 3
s_waitcnt lgkmcnt(4)
v_mfma_f32_32x32x16_bf16 v[64:79], v[116:119], v[204:207], v[64:79]
s_mov_b64 s[18:19], s[26:27]
s_mov_b32 s26, 0x1c0000
s_mov_b32 s27, 0x20000
s_lshl_b32 s44, s29, 11
v_and_b32 v54, 0x200, v1
v_mov_b32 v52, 0x3a7e3f00
v_mov_b32 v53, 0
v_mov_b32 v49, 0
v_mov_b32 v48, 0x3f803f80
s_nop 1
v_mfma_f32_32x32x8_bf16 a[240:255], v[52:53], v[48:49], 0
s_add_u32 s3, s88, s44
s_add_u32 s3, s3, 0x3ff000
s_cmp_ge_u32 s29, 1
s_cselect_b32 s41, s3, 0x80000000
s_cselect_b64 vcc, -1, 0
s_sub_u32 s3, s44, 2048
v_cndmask_b32 v48, 0, v48, vcc
v_add_u32 v50, s3, v1
v_add_u32 v51, 1024, v50
v_mfma_f32_32x32x8_bf16 a[224:239], v[52:53], v[48:49], 0
v_cndmask_b32 v246, v54, v50, vcc
v_cndmask_b32 v247, v54, v51, vcc
s_add_u32 s3, s88, s44
s_add_u32 s3, s3, 0x3ff000
s_cmp_ge_u32 s29, 2
s_cselect_b32 s40, s3, 0x80000000
s_cselect_b64 vcc, -1, 0
s_sub_u32 s3, s44, 4096
v_cndmask_b32 v48, 0, v48, vcc
v_add_u32 v50, s3, v1
v_add_u32 v51, 1024, v50
v_mfma_f32_32x32x8_bf16 a[208:223], v[52:53], v[48:49], 0
v_cndmask_b32 v244, v54, v50, vcc
v_cndmask_b32 v245, v54, v51, vcc
s_add_u32 s3, s88, s44
s_add_u32 s3, s3, 0x3fe000
s_cmp_ge_u32 s29, 3
s_cselect_b32 s39, s3, 0x80000000
s_cselect_b64 vcc, -1, 0
s_sub_u32 s3, s44, 6144
v_cndmask_b32 v48, 0, v48, vcc
v_add_u32 v50, s3, v1
v_add_u32 v51, 1024, v50
v_mfma_f32_32x32x8_bf16 a[192:207], v[52:53], v[48:49], 0
v_cndmask_b32 v242, v54, v50, vcc
v_cndmask_b32 v243, v54, v51, vcc
s_add_u32 s3, s88, s44
s_add_u32 s3, s3, 0x3fe000
s_cmp_ge_u32 s29, 4
s_cselect_b32 s38, s3, 0x80000000
s_cselect_b64 vcc, -1, 0
s_sub_u32 s3, s44, 8192
v_cndmask_b32 v48, 0, v48, vcc
v_add_u32 v50, s3, v1
v_add_u32 v51, 1024, v50
v_mfma_f32_32x32x8_bf16 a[176:191], v[52:53], v[48:49], 0
v_cndmask_b32 v240, v54, v50, vcc
v_cndmask_b32 v241, v54, v51, vcc
s_add_u32 s88, s88, 0x200000
s_add_u32 s101, s88, s44
s_waitcnt vmcnt(8) lgkmcnt(0)
s_barrier
v_mfma_f32_32x32x16_bf16 v[64:79], v[120:123], a[40:43], v[64:79]
ds_read_b64_tr_b16 v[128:129], v10 offset:49152
ds_read_b64_tr_b16 v[130:131], v10 offset:49664
ds_read_b64_tr_b16 v[136:137], v12 offset:49152
s_add_u32 m0, s36, 32768
s_add_u32 s35, s35, 0x8000
buffer_store_dwordx2 v[34:35], v36, s[12:15], 0 offen offset:128 sc1
buffer_load_dwordx2 v[38:39], v248, s[12:15], 0 offen offset:0 sc1
v_mfma_f32_32x32x16_bf16 v[64:79], v[124:127], a[44:47], v[64:79]
ds_read_b64_tr_b16 v[138:139], v12 offset:49664
ds_read_b64_tr_b16 v[144:145], v10 offset:51200
ds_read_b64_tr_b16 v[146:147], v10 offset:51712
buffer_load_dwordx4 v56, s[8:11], s35 offen offset:0 lds
v_mfma_f32_16x16x32_bf16 v[24:27], v[16:19], v[96:99], v[24:27]
ds_read_b64_tr_b16 v[152:153], v12 offset:51200
v_mfma_f32_16x16x32_bf16 v[24:27], v[16:19], v[104:107], v[24:27]
ds_read_b64_tr_b16 v[154:155], v12 offset:51712
v_mfma_f32_16x16x32_bf16 v[24:27], v[16:19], v[112:115], v[24:27]
v_mfma_f32_16x16x32_bf16 v[24:27], v[16:19], v[120:123], v[24:27]
s_waitcnt lgkmcnt(6)
v_mfma_f32_16x16x32_bf16 v[24:27], v[16:19], v[128:131], v[24:27]
ds_read_b64_tr_b16 v[132:133], v11 offset:49152
ds_read_b64_tr_b16 v[134:135], v11 offset:49664
s_waitcnt lgkmcnt(6)
v_mfma_f32_16x16x32_bf16 v[24:27], v[16:19], v[136:139], v[24:27]
ds_read_b64_tr_b16 v[140:141], v13 offset:49152
ds_read_b64_tr_b16 v[142:143], v13 offset:49664
s_waitcnt lgkmcnt(6)
v_mfma_f32_16x16x32_bf16 v[24:27], v[16:19], v[144:147], v[24:27]
ds_read_b64_tr_b16 v[148:149], v11 offset:51200
ds_read_b64_tr_b16 v[150:151], v11 offset:51712
s_waitcnt lgkmcnt(6)
v_mfma_f32_16x16x32_bf16 v[24:27], v[16:19], v[152:155], v[24:27]
ds_read_b64_tr_b16 v[156:157], v13 offset:51200
ds_read_b64_tr_b16 v[158:159], v13 offset:51712
v_mfma_f32_32x32x16_bf16 v[64:79], v[128:131], v[208:211], v[64:79]
v_mfma_f32_32x32x16_bf16 v[64:79], v[136:139], a[48:51], v[64:79]
buffer_load_dwordx4 v57, s[8:11], s35 offen offset:1024 lds
v_mfma_f32_32x32x16_bf16 v[64:79], v[144:147], v[216:219], v[64:79]
s_nop 1
ds_write_b32 v33, v24 offset:4
v_xor_b32 v20, 512, v33
buffer_load_dwordx4 v58, s[8:11], s35 offen offset:2048 lds
v_mfma_f32_32x32x16_bf16 v[64:79], v[152:155], a[56:59], v[64:79]
buffer_load_dwordx4 v59, s[8:11], s35 offen offset:3072 lds
s_waitcnt lgkmcnt(7)
v_mfma_f32_32x32x16_bf16 v[64:79], v[132:135], v[212:215], v[64:79]
v_and_b32 v3, 0xfffffe0f, v253
ds_read_b128 a[168:171], v253 offset:0
ds_read_b128 a[172:175], v253 offset:1024
s_waitcnt lgkmcnt(2)
s_barrier
ds_read_b32 v20, v20 offset:4
v_mfma_f32_32x32x16_bf16 v[64:79], v[140:143], a[52:55], v[64:79]
ds_read_b128 v[224:227], v3 offset:0
ds_read_b128 v[228:231], v3 offset:1024
v_mfma_f32_32x32x16_bf16 v[64:79], v[148:151], v[220:223], v[64:79]
v_mul_f32 v32, 0x3eb8aa3b, v32
v_mfma_f32_32x32x16_bf16 v[64:79], v[156:159], a[60:63], v[64:79]
s_waitcnt lgkmcnt(2)
v_add_f32 v20, v20, v24
v_cvt_pk_bf16_f32 v30, v20, v20
v_and_b32 v21, 0xffff0000, v30
v_sub_f32 v21, v20, v21
v_cvt_pk_bf16_f32 v31, v21, v21
s_nop 1
v_mfma_f32_32x32x8_bf16 v[64:79], v[30:31], v[28:29], v[64:79]
s_waitcnt vmcnt(4)
v_cmp_eq_u64 vcc, s[82:83], v[38:39]
s_nop 0
s_cmp_eq_u32 vcc_lo, 0xf
s_cbranch_scc0 L_spin_k
L_ok_k:
buffer_load_dwordx4 a[136:139], v240, s[12:15], s88 offen sc1
buffer_load_dwordx4 a[140:143], v241, s[12:15], s88 offen sc1
buffer_load_dwordx4 a[144:147], v242, s[12:15], s88 offen sc1
s_nop 3
v_mul_f32 v64, v32, v64
v_mul_f32 v65, v32, v65
v_mul_f32 v66, v32, v66
v_mul_f32 v67, v32, v67
v_mul_f32 v68, v32, v68
buffer_load_dwordx4 a[148:151], v243, s[12:15], s88 offen sc1
v_mul_f32 v69, v32, v69
v_mul_f32 v70, v32, v70
v_mul_f32 v71, v32, v71
v_cvt_pk_bf16_f32 v40, v64, v65
v_cvt_pk_bf16_f32 v41, v66, v67
buffer_load_dwordx4 a[152:155], v244, s[12:15], s88 offen sc1
v_cvt_pk_bf16_f32 v42, v68, v69
v_cvt_pk_bf16_f32 v43, v70, v71
ds_write_b128 v252, v[40:43] offset:8192
v_mul_f32 v72, v32, v72
v_mul_f32 v73, v32, v73
buffer_load_dwordx4 a[156:159], v245, s[12:15], s88 offen sc1
v_mul_f32 v74, v32, v74
v_mul_f32 v75, v32, v75
v_mul_f32 v76, v32, v76
v_mul_f32 v77, v32, v77
v_mul_f32 v78, v32, v78
buffer_load_dwordx4 a[160:163], v246, s[12:15], s88 offen sc1
v_mul_f32 v79, v32, v79
v_cvt_pk_bf16_f32 v44, v72, v73
v_cvt_pk_bf16_f32 v45, v74, v75
v_cvt_pk_bf16_f32 v46, v76, v77
v_cvt_pk_bf16_f32 v47, v78, v79
buffer_load_dwordx4 a[164:167], v247, s[12:15], s88 offen sc1
ds_write_b128 v252, v[44:47] offset:10240
buffer_load_dwordx2 v[38:39], v248, s[12:15], 0 offen offset:128 sc1
s_waitcnt lgkmcnt(0)
s_barrier
ds_read_b128 v[40:43], v253 offset:8192
ds_read_b128 v[44:47], v253 offset:9216
v_xor_b32 v224, 0x80008000, v224
v_xor_b32 v225, 0x80008000, v225
v_xor_b32 v226, 0x80008000, v226
v_xor_b32 v227, 0x80008000, v227
v_xor_b32 v228, 0x80008000, v228
v_xor_b32 v229, 0x80008000, v229
v_xor_b32 v230, 0x80008000, v230
v_xor_b32 v231, 0x80008000, v231
s_waitcnt lgkmcnt(1)
v_mfma_f32_32x32x16_bf16 v[112:127], v[224:227], v[40:43], 0
v_mfma_f32_32x32x16_bf16 v[128:143], a[168:171], v[40:43], v[112:127]
s_waitcnt vmcnt(8)
v_mfma_f32_32x32x16_bf16 v[64:79], a[136:139], v[40:43], v[112:127]
s_waitcnt vmcnt(7)
v_mfma_f32_32x32x16_bf16 v[80:95], a[140:143], v[40:43], v[112:127]
s_add_u32 m0, s36, 49152
s_add_u32 s35, s35, 0x8000
buffer_load_dwordx4 v56, s[8:11], s35 offen offset:0 lds
s_nop 6
v_cndmask_b32 v128, v64, v128, s[48:49]
v_cndmask_b32 v129, v65, v129, s[50:51]
v_cndmask_b32 v130, v66, v130, s[52:53]
v_cndmask_b32 v131, v67, v131, s[54:55]
v_cndmask_b32 v132, v68, v132, s[56:57]
v_cndmask_b32 v133, v69, v133, s[58:59]
v_cndmask_b32 v134, v70, v134, s[60:61]
v_cndmask_b32 v135, v71, v135, s[62:63]
v_cndmask_b32 v136, v72, v136, s[64:65]
v_cndmask_b32 v137, v73, v137, s[66:67]
v_cndmask_b32 v138, v74, v138, s[68:69]
v_cndmask_b32 v139, v75, v139, s[70:71]
v_cndmask_b32 v140, v76, v140, s[72:73]
v_cndmask_b32 v141, v77, v141, s[74:75]
buffer_load_dwordx4 v57, s[8:11], s35 offen offset:1024 lds
v_cndmask_b32 v142, v78, v142, s[76:77]
v_cndmask_b32 v143, v79, v143, s[78:79]
v_exp_f32 v128, v128
v_exp_f32 v129, v129
v_exp_f32 v130, v130
v_exp_f32 v131, v131
v_cvt_pk_bf16_f32 v168, v128, v129
v_exp_f32 v132, v132
v_exp_f32 v133, v133
v_cvt_pk_bf16_f32 v169, v130, v131
v_exp_f32 v134, v134
v_exp_f32 v135, v135
v_cvt_pk_bf16_f32 v170, v132, v133
v_exp_f32 v136, v136
buffer_load_dwordx4 v58, s[8:11], s35 offen offset:2048 lds
v_exp_f32 v137, v137
v_cvt_pk_bf16_f32 v171, v134, v135
v_exp_f32 v138, v138
v_exp_f32 v139, v139
v_cvt_pk_bf16_f32 v172, v136, v137
v_exp_f32 v140, v140
v_exp_f32 v141, v141
v_cvt_pk_bf16_f32 v173, v138, v139
v_exp_f32 v142, v142
v_exp_f32 v143, v143
v_cvt_pk_bf16_f32 v174, v140, v141
v_and_b32 v160, v232, v168
v_cvt_pk_bf16_f32 v175, v142, v143
v_and_b32 v161, v233, v169
buffer_load_dwordx4 v59, s[8:11], s35 offen offset:3072 lds
v_and_b32 v162, v234, v170
v_and_b32 v163, v235, v171
v_and_b32 v164, v236, v172
v_and_b32 v165, v237, v173
v_and_b32 v166, v238, v174
v_and_b32 v167, v239, v175
v_xor_b32 v168, v160, v168
v_xor_b32 v169, v161, v169
v_xor_b32 v170, v162, v170
v_xor_b32 v171, v163, v171
v_xor_b32 v172, v164, v172
v_xor_b32 v173, v165, v173
v_xor_b32 v174, v166, v174
v_xor_b32 v175, v167, v175
s_waitcnt vmcnt(4)
v_cmp_eq_u64 vcc, s[82:83], v[38:39]
s_nop 0
s_cmp_eq_u32 vcc_lo, 0xf
s_cbranch_scc0 L_spin_v
L_ok_v:
v_mfma_f32_32x32x16_bf16 v[64:79], a[144:147], v[40:43], v[112:127]
s_mul_i32 s3, s28, 10240
s_add_u32 m0, s3, 122880
v_exp_f32 v80, v80
v_exp_f32 v81, v81
buffer_load_dwordx4 v1, s[12:15], s38 offen offset:0 sc1 lds
v_exp_f32 v82, v82
v_exp_f32 v83, v83
v_cvt_pk_bf16_f32 v176, v80, v81
buffer_load_dwordx4 v1, s[12:15], s38 offen offset:1024 sc1 lds
v_exp_f32 v84, v84
v_exp_f32 v85, v85
buffer_load_dwordx4 v1, s[12:15], s39 offen offset:2048 sc1 lds
v_cvt_pk_bf16_f32 v177, v82, v83
v_exp_f32 v86, v86
v_exp_f32 v87, v87
buffer_load_dwordx4 v1, s[12:15], s39 offen offset:3072 sc1 lds
s_add_u32 m0, s3, 126976
v_cvt_pk_bf16_f32 v178, v84, v85
v_exp_f32 v88, v88
buffer_load_dwordx4 v1, s[12:15], s40 offen offset:0 sc1 lds
v_exp_f32 v89, v89
v_cvt_pk_bf16_f32 v179, v86, v87
v_exp_f32 v90, v90
buffer_load_dwordx4 v1, s[12:15], s40 offen offset:1024 sc1 lds
v_exp_f32 v91, v91
v_cvt_pk_bf16_f32 v180, v88, v89
buffer_load_dwordx4 v1, s[12:15], s41 offen offset:2048 sc1 lds
v_exp_f32 v92, v92
v_exp_f32 v93, v93
v_cvt_pk_bf16_f32 v181, v90, v91
buffer_load_dwordx4 v1, s[12:15], s41 offen offset:3072 sc1 lds
v_exp_f32 v94, v94
v_exp_f32 v95, v95
v_cvt_pk_bf16_f32 v182, v92, v93
v_cvt_pk_bf16_f32 v183, v94, v95
v_mfma_f32_32x32x16_bf16 v[80:95], a[148:151], v[40:43], v[112:127]
v_exp_f32 v64, v64
v_exp_f32 v65, v65
v_exp_f32 v66, v66
v_exp_f32 v67, v67
v_cvt_pk_bf16_f32 v184, v64, v65
v_exp_f32 v68, v68
v_exp_f32 v69, v69
v_cvt_pk_bf16_f32 v185, v66, v67
v_exp_f32 v70, v70
v_exp_f32 v71, v71
v_cvt_pk_bf16_f32 v186, v68, v69
v_exp_f32 v72, v72
v_exp_f32 v73, v73
v_cvt_pk_bf16_f32 v187, v70, v71
v_exp_f32 v74, v74
v_exp_f32 v75, v75
v_cvt_pk_bf16_f32 v188, v72, v73
v_exp_f32 v76, v76
v_exp_f32 v77, v77
v_cvt_pk_bf16_f32 v189, v74, v75
v_exp_f32 v78, v78
v_exp_f32 v79, v79
v_cvt_pk_bf16_f32 v190, v76, v77
v_cvt_pk_bf16_f32 v191, v78, v79
v_mfma_f32_32x32x16_bf16 v[64:79], a[152:155], v[40:43], v[112:127]
s_lshr_b32 m0, s36, 1
s_add_u32 m0, m0, 114688
v_accvgpr_read_b32 v63, a132
buffer_load_dwordx4 v56, s[24:27], s91 offen  lds
v_exp_f32 v80, v80
v_exp_f32 v81, v81
v_exp_f32 v82, v82
buffer_load_dwordx4 v57, s[24:27], s91 offen offset:1024  lds
v_xor_b32 v8, 64, v63
v_exp_f32 v83, v83
v_cvt_pk_bf16_f32 v192, v80, v81
v_exp_f32 v84, v84
v_exp_f32 v85, v85
s_add_u32 m0, s36, 65536
s_add_u32 s0, s0, 1
s_and_b32 s0, s0, 7
s_mul_i32 s1, s0, 229376
buffer_load_dwordx4 v60, s[20:23], s1 offen offset:0  lds
v_cvt_pk_bf16_f32 v193, v82, v83
v_exp_f32 v86, v86
v_exp_f32 v87, v87
v_cvt_pk_bf16_f32 v194, v84, v85
buffer_load_dwordx4 v61, s[20:23], s1 offen offset:1024  lds
v_exp_f32 v88, v88
v_exp_f32 v89, v89
v_cvt_pk_bf16_f32 v195, v86, v87
v_exp_f32 v90, v90
buffer_load_dwordx4 v14, s[4:7], s1 offen offset:2048  lds
v_exp_f32 v91, v91
v_cvt_pk_bf16_f32 v196, v88, v89
v_exp_f32 v92, v92
v_exp_f32 v93, v93
buffer_load_dwordx4 v15, s[4:7], s1 offen offset:3072  lds
v_cvt_pk_bf16_f32 v197, v90, v91
v_exp_f32 v94, v94
v_exp_f32 v95, v95
v_cvt_pk_bf16_f32 v198, v92, v93
v_cvt_pk_bf16_f32 v199, v94, v95
v_mfma_f32_32x32x16_bf16 v[80:95], a[156:159], v[40:43], v[112:127]
s_waitcnt vmcnt(10)
s_mov_b64 exec, s[80:81]
ds_read_b128 a[240:243], v249 offset:8192
ds_read_b128 a[244:247], v249 offset:8704
ds_read_b128 a[176:179], v249 offset:0
ds_read_b128 a[180:183], v249 offset:512
ds_read_b128 a[184:187], v249 offset:1024
ds_read_b128 a[188:191], v249 offset:1536
ds_read_b128 a[192:195], v249 offset:2048
ds_read_b128 a[196:199], v249 offset:2560
ds_read_b128 a[200:203], v249 offset:3072
ds_read_b128 a[204:207], v249 offset:3584
s_mov_b64 exec, -1
v_exp_f32 v64, v64
v_exp_f32 v65, v65
v_exp_f32 v66, v66
v_exp_f32 v67, v67
v_cvt_pk_bf16_f32 v200, v64, v65
v_exp_f32 v68, v68
v_exp_f32 v69, v69
v_cvt_pk_bf16_f32 v201, v66, v67
v_exp_f32 v70, v70
v_exp_f32 v71, v71
v_cvt_pk_bf16_f32 v202, v68, v69
v_exp_f32 v72, v72
v_exp_f32 v73, v73
v_cvt_pk_bf16_f32 v203, v70, v71
v_exp_f32 v74, v74
v_exp_f32 v75, v75
v_cvt_pk_bf16_f32 v204, v72, v73
v_exp_f32 v76, v76
v_exp_f32 v77, v77
v_cvt_pk_bf16_f32 v205, v74, v75
v_exp_f32 v78, v78
v_exp_f32 v79, v79
v_cvt_pk_bf16_f32 v206, v76, v77
v_cvt_pk_bf16_f32 v207, v78, v79
v_mfma_f32_32x32x16_bf16 v[64:79], a[160:163], v[40:43], v[112:127]
v_exp_f32 v80, v80
v_exp_f32 v81, v81
v_exp_f32 v82, v82
s_waitcnt lgkmcnt(9)
v_mfma_f32_32x32x16_bf16 v[144:159], a[240:243], v[160:163], 0
v_exp_f32 v83, v83
v_cvt_pk_bf16_f32 v208, v80, v81
v_exp_f32 v84, v84
v_exp_f32 v85, v85
s_waitcnt lgkmcnt(8)
v_mfma_f32_32x32x16_bf16 v[144:159], a[244:247], v[164:167], v[144:159]
v_cvt_pk_bf16_f32 v209, v82, v83
v_exp_f32 v86, v86
v_exp_f32 v87, v87
v_cvt_pk_bf16_f32 v210, v84, v85
s_waitcnt lgkmcnt(7)
v_mfma_f32_32x32x16_bf16 v[144:159], a[176:179], v[168:171], v[144:159]
v_exp_f32 v88, v88
v_exp_f32 v89, v89
v_cvt_pk_bf16_f32 v211, v86, v87
v_exp_f32 v90, v90
s_waitcnt lgkmcnt(6)
v_mfma_f32_32x32x16_bf16 v[144:159], a[180:183], v[172:175], v[144:159]
v_exp_f32 v91, v91
v_cvt_pk_bf16_f32 v212, v88, v89
v_exp_f32 v92, v92
v_exp_f32 v93, v93
s_waitcnt lgkmcnt(5)
v_mfma_f32_32x32x16_bf16 v[144:159], a[184:187], v[176:179], v[144:159]
v_cvt_pk_bf16_f32 v213, v90, v91
v_exp_f32 v94, v94
v_exp_f32 v95, v95
v_cvt_pk_bf16_f32 v214, v92, v93
s_waitcnt lgkmcnt(4)
v_mfma_f32_32x32x16_bf16 v[144:159], a[188:191], v[180:183], v[144:159]
v_cvt_pk_bf16_f32 v215, v94, v95
v_mfma_f32_32x32x16_bf16 v[80:95], a[164:167], v[40:43], v[112:127]
s_waitcnt vmcnt(6)
s_mov_b64 exec, s[80:81]
ds_read_b128 a[208:211], v249 offset:4096
ds_read_b128 a[212:215], v249 offset:4608
ds_read_b128 a[216:219], v249 offset:5120
ds_read_b128 a[220:223], v249 offset:5632
ds_read_b128 a[224:227], v249 offset:6144
ds_read_b128 a[228:231], v249 offset:6656
ds_read_b128 a[232:235], v249 offset:7168
ds_read_b128 a[236:239], v249 offset:7680
ds_read_b128 a[248:251], v249 offset:9216
ds_read_b128 a[252:255], v249 offset:9728
s_mov_b64 exec, -1
s_waitcnt lgkmcnt(13)
v_mfma_f32_32x32x16_bf16 v[144:159], a[192:195], v[184:187], v[144:159]
v_exp_f32 v64, v64
v_exp_f32 v65, v65
s_waitcnt lgkmcnt(12)
v_mfma_f32_32x32x16_bf16 v[144:159], a[196:199], v[188:191], v[144:159]
v_exp_f32 v66, v66
v_exp_f32 v67, v67
s_add_u32 m0, s36, 81920
s_add_u32 s0, s0, 1
s_and_b32 s0, s0, 7
s_mul_i32 s1, s0, 229376
s_waitcnt lgkmcnt(11)
v_mfma_f32_32x32x16_bf16 v[144:159], a[200:203], v[192:195], v[144:159]
buffer_load_dwordx4 v60, s[20:23], s1 offen offset:0  lds
v_cvt_pk_bf16_f32 v216, v64, v65
v_exp_f32 v68, v68
v_exp_f32 v69, v69
v_cvt_pk_bf16_f32 v217, v66, v67
v_exp_f32 v70, v70
s_waitcnt lgkmcnt(10)
v_mfma_f32_32x32x16_bf16 v[144:159], a[204:207], v[196:199], v[144:159]
buffer_load_dwordx4 v61, s[20:23], s1 offen offset:1024  lds
v_exp_f32 v71, v71
v_cvt_pk_bf16_f32 v218, v68, v69
v_exp_f32 v72, v72
v_exp_f32 v73, v73
s_waitcnt lgkmcnt(9)
v_mfma_f32_32x32x16_bf16 v[144:159], a[208:211], v[200:203], v[144:159]
buffer_load_dwordx4 v14, s[4:7], s1 offen offset:2048  lds
v_cvt_pk_bf16_f32 v219, v70, v71
v_exp_f32 v74, v74
v_exp_f32 v75, v75
v_cvt_pk_bf16_f32 v220, v72, v73
v_exp_f32 v76, v76
s_waitcnt lgkmcnt(8)
v_mfma_f32_32x32x16_bf16 v[144:159], a[212:215], v[204:207], v[144:159]
buffer_load_dwordx4 v15, s[4:7], s1 offen offset:3072  lds
v_exp_f32 v77, v77
v_cvt_pk_bf16_f32 v221, v74, v75
v_exp_f32 v78, v78
v_exp_f32 v79, v79
v_cvt_pk_bf16_f32 v222, v76, v77
v_cvt_pk_bf16_f32 v223, v78, v79
v_mfma_f32_32x32x16_bf16 v[112:127], v[228:231], v[44:47], 0
v_exp_f32 v80, v80
v_exp_f32 v81, v81
v_exp_f32 v82, v82
s_waitcnt lgkmcnt(7)
v_mfma_f32_32x32x16_bf16 v[144:159], a[216:219], v[208:211], v[144:159]
v_exp_f32 v83, v83
v_cvt_pk_bf16_f32 v224, v80, v81
v_exp_f32 v84, v84
v_exp_f32 v85, v85
s_waitcnt lgkmcnt(6)
v_mfma_f32_32x32x16_bf16 v[144:159], a[220:223], v[212:215], v[144:159]
v_cvt_pk_bf16_f32 v225, v82, v83
v_exp_f32 v86, v86
v_exp_f32 v87, v87
v_cvt_pk_bf16_f32 v226, v84, v85
s_waitcnt lgkmcnt(5)
v_mfma_f32_32x32x16_bf16 v[144:159], a[224:227], v[216:219], v[144:159]
v_exp_f32 v88, v88
v_exp_f32 v89, v89
v_cvt_pk_bf16_f32 v227, v86, v87
v_exp_f32 v90, v90
s_waitcnt lgkmcnt(4)
v_mfma_f32_32x32x16_bf16 v[144:159], a[228:231], v[220:223], v[144:159]
v_exp_f32 v91, v91
v_cvt_pk_bf16_f32 v228, v88, v89
v_exp_f32 v92, v92
v_exp_f32 v93, v93
v_mfma_f32_32x32x16_bf16 v[128:143], a[172:175], v[44:47], v[112:127]
v_cvt_pk_bf16_f32 v229, v90, v91
v_exp_f32 v94, v94
v_exp_f32 v95, v95
v_cvt_pk_bf16_f32 v230, v92, v93
v_mfma_f32_32x32x16_bf16 v[64:79], a[140:143], v[44:47], v[112:127]
v_cvt_pk_bf16_f32 v231, v94, v95
s_waitcnt lgkmcnt(3)
v_mfma_f32_32x32x16_bf16 v[144:159], a[232:235], v[224:227], v[144:159]
s_nop 8
v_cndmask_b32 v128, v64, v128, s[48:49]
v_cndmask_b32 v129, v65, v129, s[50:51]
v_cndmask_b32 v130, v66, v130, s[52:53]
v_cndmask_b32 v131, v67, v131, s[54:55]
v_cndmask_b32 v132, v68, v132, s[56:57]
v_cndmask_b32 v133, v69, v133, s[58:59]
v_cndmask_b32 v134, v70, v134, s[60:61]
v_cndmask_b32 v135, v71, v135, s[62:63]
s_waitcnt lgkmcnt(2)
v_mfma_f32_32x32x16_bf16 v[144:159], a[236:239], v[228:231], v[144:159]
v_cndmask_b32 v136, v72, v136, s[64:65]
v_cndmask_b32 v137, v73, v137, s[66:67]
v_cndmask_b32 v138, v74, v138, s[68:69]
v_cndmask_b32 v139, v75, v139, s[70:71]
v_cndmask_b32 v140, v76, v140, s[72:73]
v_cndmask_b32 v141, v77, v141, s[74:75]
v_cndmask_b32 v142, v78, v142, s[76:77]
v_cndmask_b32 v143, v79, v143, s[78:79]
v_mfma_f32_32x32x16_bf16 v[80:95], a[144:147], v[44:47], v[112:127]
v_exp_f32 v128, v128
v_exp_f32 v129, v129
v_exp_f32 v130, v130
v_exp_f32 v131, v131
v_cvt_pk_bf16_f32 v168, v128, v129
v_exp_f32 v132, v132
v_exp_f32 v133, v133
v_cvt_pk_bf16_f32 v169, v130, v131
v_exp_f32 v134, v134
v_exp_f32 v135, v135
v_cvt_pk_bf16_f32 v170, v132, v133
v_exp_f32 v136, v136
v_exp_f32 v137, v137
v_cvt_pk_bf16_f32 v171, v134, v135
v_exp_f32 v138, v138
v_exp_f32 v139, v139
v_cvt_pk_bf16_f32 v172, v136, v137
v_exp_f32 v140, v140
v_exp_f32 v141, v141
v_cvt_pk_bf16_f32 v173, v138, v139
v_cmp_gt_f32 vcc, 0x53800000, v152
s_nop 0
s_cmp_eq_u64 vcc, -1
s_cbranch_scc0 L_redo0
L_fin0:
v_rcp_f32 v54, v152
s_nop 0
v_mul_f32 v144, v54, v144
v_mul_f32 v145, v54, v145
v_mul_f32 v146, v54, v146
v_mul_f32 v147, v54, v147
v_mul_f32 v148, v54, v148
v_mul_f32 v149, v54, v149
v_mul_f32 v150, v54, v150
v_mul_f32 v151, v54, v151
v_cvt_pk_bf16_f32 v48, v144, v145
v_cvt_pk_bf16_f32 v49, v146, v147
v_cvt_pk_bf16_f32 v50, v148, v149
v_cvt_pk_bf16_f32 v51, v150, v151
buffer_store_dwordx4 v[48:51], v1, s[12:15], s89 offen sc1
v_exp_f32 v142, v142
v_exp_f32 v143, v143
v_cvt_pk_bf16_f32 v174, v140, v141
v_and_b32 v160, v232, v168
v_cvt_pk_bf16_f32 v175, v142, v143
v_and_b32 v161, v233, v169
v_and_b32 v162, v234, v170
v_and_b32 v163, v235, v171
v_and_b32 v164, v236, v172
v_and_b32 v165, v237, v173
v_and_b32 v166, v238, v174
v_and_b32 v167, v239, v175
v_xor_b32 v168, v160, v168
v_xor_b32 v169, v161, v169
v_xor_b32 v170, v162, v170
v_xor_b32 v171, v163, v171
v_xor_b32 v172, v164, v172
v_xor_b32 v173, v165, v173
v_xor_b32 v174, v166, v174
v_xor_b32 v175, v167, v175
s_waitcnt vmcnt(9)
ds_read_b64_tr_b16 v[20:21], v63 offset:0
ds_read_b64_tr_b16 v[22:23], v63 offset:1024
ds_read_b64_tr_b16 v[24:25], v8 offset:0
ds_read_b64_tr_b16 v[26:27], v8 offset:1024
v_mfma_f32_32x32x16_bf16 v[64:79], a[148:151], v[44:47], v[112:127]
v_exp_f32 v80, v80
v_exp_f32 v81, v81
v_exp_f32 v82, v82
v_exp_f32 v83, v83
s_waitcnt lgkmcnt(5)
v_mfma_f32_32x32x16_bf16 v[128:143], a[248:251], v[160:163], 0
v_cvt_pk_bf16_f32 v176, v80, v81
v_exp_f32 v84, v84
v_exp_f32 v85, v85
s_waitcnt lgkmcnt(2)
buffer_store_dwordx4 v[20:23], v1, s[12:15], s86 offen offset:0 sc1
v_cvt_pk_bf16_f32 v177, v82, v83
v_exp_f32 v86, v86
v_mfma_f32_32x32x16_bf16 v[128:143], a[252:255], v[164:167], v[128:143]
v_exp_f32 v87, v87
v_cvt_pk_bf16_f32 v178, v84, v85
v_exp_f32 v88, v88
v_exp_f32 v89, v89
v_cvt_pk_bf16_f32 v179, v86, v87
v_mfma_f32_32x32x16_bf16 v[128:143], a[184:187], v[168:171], v[128:143]
v_exp_f32 v90, v90
s_waitcnt lgkmcnt(0)
buffer_store_dwordx4 v[24:27], v1, s[12:15], s86 offen offset:1024 sc1
v_exp_f32 v91, v91
v_cvt_pk_bf16_f32 v180, v88, v89
v_exp_f32 v92, v92
v_mfma_f32_32x32x16_bf16 v[128:143], a[188:191], v[172:175], v[128:143]
v_exp_f32 v93, v93
v_cvt_pk_bf16_f32 v181, v90, v91
v_exp_f32 v94, v94
v_exp_f32 v95, v95
v_cvt_pk_bf16_f32 v182, v92, v93
v_cvt_pk_bf16_f32 v183, v94, v95
v_mfma_f32_32x32x16_bf16 v[80:95], a[152:155], v[44:47], v[112:127]
s_add_u32 m0, s36, 98304
s_add_u32 s0, s0, 1
s_and_b32 s0, s0, 7
s_mul_i32 s1, s0, 229376
buffer_load_dwordx4 v60, s[20:23], s1 offen offset:0  lds
v_exp_f32 v64, v64
v_exp_f32 v65, v65
v_exp_f32 v66, v66
v_exp_f32 v67, v67
v_cvt_pk_bf16_f32 v184, v64, v65
buffer_load_dwordx4 v61, s[20:23], s1 offen offset:1024  lds
v_mfma_f32_32x32x16_bf16 v[128:143], a[192:195], v[176:179], v[128:143]
v_exp_f32 v68, v68
v_exp_f32 v69, v69
v_cvt_pk_bf16_f32 v185, v66, v67
v_exp_f32 v70, v70
v_exp_f32 v71, v71
v_cvt_pk_bf16_f32 v186, v68, v69
buffer_load_dwordx4 v14, s[4:7], s1 offen offset:2048  lds
v_exp_f32 v72, v72
v_exp_f32 v73, v73
v_mfma_f32_32x32x16_bf16 v[128:143], a[196:199], v[180:183], v[128:143]
v_cvt_pk_bf16_f32 v187, v70, v71
v_exp_f32 v74, v74
v_exp_f32 v75, v75
v_cvt_pk_bf16_f32 v188, v72, v73
buffer_load_dwordx4 v15, s[4:7], s1 offen offset:3072  lds
v_exp_f32 v76, v76
v_exp_f32 v77, v77
v_cvt_pk_bf16_f32 v189, v74, v75
v_exp_f32 v78, v78
v_exp_f32 v79, v79
v_cvt_pk_bf16_f32 v190, v76, v77
v_cvt_pk_bf16_f32 v191, v78, v79
v_mfma_f32_32x32x16_bf16 v[64:79], a[156:159], v[44:47], v[112:127]
v_exp_f32 v80, v80
v_exp_f32 v81, v81
v_exp_f32 v82, v82
v_exp_f32 v83, v83
v_cvt_pk_bf16_f32 v192, v80, v81
v_exp_f32 v84, v84
v_exp_f32 v85, v85
v_mfma_f32_32x32x16_bf16 v[128:143], a[200:203], v[184:187], v[128:143]
v_cvt_pk_bf16_f32 v193, v82, v83
v_exp_f32 v86, v86
v_exp_f32 v87, v87
v_cvt_pk_bf16_f32 v194, v84, v85
v_exp_f32 v88, v88
v_exp_f32 v89, v89
v_cvt_pk_bf16_f32 v195, v86, v87
v_exp_f32 v90, v90
v_mfma_f32_32x32x16_bf16 v[128:143], a[204:207], v[188:191], v[128:143]
v_exp_f32 v91, v91
v_cvt_pk_bf16_f32 v196, v88, v89
v_exp_f32 v92, v92
v_exp_f32 v93, v93
v_cvt_pk_bf16_f32 v197, v90, v91
v_exp_f32 v94, v94
v_exp_f32 v95, v95
v_cvt_pk_bf16_f32 v198, v92, v93
v_cvt_pk_bf16_f32 v199, v94, v95
s_waitcnt vmcnt(6)
s_barrier
buffer_store_dwordx2 v[34:35], v36, s[12:15], 0 offen offset:384 sc1
v_accvgpr_read_b32 v3, a133
s_lshl_b32 s35, s28, 13
s_lshl_b32 s44, s29, 16
s_add_u32 s44, s44, s35
s_add_u32 s44, s44, 0x600000
v_mfma_f32_32x32x16_bf16 v[80:95], a[160:163], v[44:47], v[112:127]
s_add_u32 m0, s36, 114688
s_add_u32 s0, s0, 1
s_and_b32 s0, s0, 7
s_mul_i32 s1, s0, 229376
buffer_load_dwordx4 v60, s[20:23], s1 offen offset:0  lds
v_exp_f32 v64, v64
v_exp_f32 v65, v65
buffer_load_dwordx4 v61, s[20:23], s1 offen offset:1024  lds
v_exp_f32 v66, v66
v_exp_f32 v67, v67
buffer_load_dwordx4 v14, s[4:7], s1 offen offset:2048  lds
v_cvt_pk_bf16_f32 v200, v64, v65
v_exp_f32 v68, v68
buffer_load_dwordx4 v15, s[4:7], s1 offen offset:3072  lds
v_mfma_f32_32x32x16_bf16 v[128:143], a[208:211], v[192:195], v[128:143]
v_exp_f32 v69, v69
v_cvt_pk_bf16_f32 v201, v66, v67
v_exp_f32 v70, v70
ds_read_b64_tr_b16 a[0:1], v3 offset:0
ds_read_b64_tr_b16 a[2:3], v3 offset:1024
v_exp_f32 v71, v71
v_cvt_pk_bf16_f32 v202, v68, v69
ds_read_b64_tr_b16 a[4:5], v3 offset:16384
ds_read_b64_tr_b16 a[6:7], v3 offset:17408
v_exp_f32 v72, v72
v_exp_f32 v73, v73
ds_read_b64_tr_b16 a[8:9], v3 offset:32768
ds_read_b64_tr_b16 a[10:11], v3 offset:33792
v_cvt_pk_bf16_f32 v203, v70, v71
v_mfma_f32_32x32x16_bf16 v[128:143], a[212:215], v[196:199], v[128:143]
v_exp_f32 v74, v74
v_exp_f32 v75, v75
ds_read_b64_tr_b16 a[12:13], v3 offset:49152
ds_read_b64_tr_b16 a[14:15], v3 offset:50176
v_cvt_pk_bf16_f32 v204, v72, v73
v_exp_f32 v76, v76
ds_read_b64_tr_b16 a[16:17], v3 offset:4096
ds_read_b64_tr_b16 a[18:19], v3 offset:5120
v_exp_f32 v77, v77
v_cvt_pk_bf16_f32 v205, v74, v75
ds_read_b64_tr_b16 a[20:21], v3 offset:20480
ds_read_b64_tr_b16 a[22:23], v3 offset:21504
v_exp_f32 v78, v78
v_exp_f32 v79, v79
v_cvt_pk_bf16_f32 v206, v76, v77
v_cvt_pk_bf16_f32 v207, v78, v79
v_mfma_f32_32x32x16_bf16 v[64:79], a[164:167], v[44:47], v[112:127]
v_exp_f32 v80, v80
v_exp_f32 v81, v81
v_exp_f32 v82, v82
v_exp_f32 v83, v83
v_cvt_pk_bf16_f32 v208, v80, v81
v_exp_f32 v84, v84
v_exp_f32 v85, v85
v_mfma_f32_32x32x16_bf16 v[128:143], a[216:219], v[200:203], v[128:143]
v_cvt_pk_bf16_f32 v209, v82, v83
v_exp_f32 v86, v86
v_exp_f32 v87, v87
v_cvt_pk_bf16_f32 v210, v84, v85
v_exp_f32 v88, v88
v_exp_f32 v89, v89
v_cvt_pk_bf16_f32 v211, v86, v87
v_exp_f32 v90, v90
v_mfma_f32_32x32x16_bf16 v[128:143], a[220:223], v[204:207], v[128:143]
v_exp_f32 v91, v91
v_cvt_pk_bf16_f32 v212, v88, v89
v_exp_f32 v92, v92
v_exp_f32 v93, v93
v_cvt_pk_bf16_f32 v213, v90, v91
v_exp_f32 v94, v94
v_exp_f32 v95, v95
v_cvt_pk_bf16_f32 v214, v92, v93
v_cvt_pk_bf16_f32 v215, v94, v95
s_waitcnt vmcnt(9)
s_barrier
buffer_store_dwordx2 v[34:35], v36, s[12:15], 0 offen offset:896 sc1
v_mfma_f32_32x32x16_bf16 v[80:95], a[168:171], v[44:47], v[112:127]
ds_read_b64_tr_b16 a[24:25], v3 offset:36864
ds_read_b64_tr_b16 a[26:27], v3 offset:37888
v_exp_f32 v64, v64
v_exp_f32 v65, v65
v_exp_f32 v66, v66
ds_read_b64_tr_b16 a[28:29], v3 offset:53248
ds_read_b64_tr_b16 a[30:31], v3 offset:54272
v_exp_f32 v67, v67
v_cvt_pk_bf16_f32 v216, v64, v65
v_exp_f32 v68, v68
v_exp_f32 v69, v69
v_mfma_f32_32x32x16_bf16 v[128:143], a[224:227], v[208:211], v[128:143]
ds_read_b64_tr_b16 a[32:33], v3 offset:8192
ds_read_b64_tr_b16 a[34:35], v3 offset:9216
v_cvt_pk_bf16_f32 v217, v66, v67
v_exp_f32 v70, v70
v_exp_f32 v71, v71
v_cvt_pk_bf16_f32 v218, v68, v69
ds_read_b64_tr_b16 a[36:37], v3 offset:24576
ds_read_b64_tr_b16 a[38:39], v3 offset:25600
v_exp_f32 v72, v72
v_exp_f32 v73, v73
v_cvt_pk_bf16_f32 v219, v70, v71
v_exp_f32 v74, v74
v_mfma_f32_32x32x16_bf16 v[128:143], a[228:231], v[212:215], v[128:143]
ds_read_b64_tr_b16 a[40:41], v3 offset:40960
ds_read_b64_tr_b16 a[42:43], v3 offset:41984
v_exp_f32 v75, v75
v_cvt_pk_bf16_f32 v220, v72, v73
v_exp_f32 v76, v76
v_exp_f32 v77, v77
ds_read_b64_tr_b16 a[44:45], v3 offset:57344
ds_read_b64_tr_b16 a[46:47], v3 offset:58368
v_cvt_pk_bf16_f32 v221, v74, v75
v_exp_f32 v78, v78
v_exp_f32 v79, v79
v_cvt_pk_bf16_f32 v222, v76, v77
v_cvt_pk_bf16_f32 v223, v78, v79
v_mfma_f32_32x32x16_bf16 v[128:143], a[232:235], v[216:219], v[128:143]
ds_read_b64_tr_b16 a[48:49], v3 offset:12288
ds_read_b64_tr_b16 a[50:51], v3 offset:13312
v_exp_f32 v80, v80
v_exp_f32 v81, v81
v_exp_f32 v82, v82
v_exp_f32 v83, v83
ds_read_b64_tr_b16 a[52:53], v3 offset:28672
ds_read_b64_tr_b16 a[54:55], v3 offset:29696
v_cvt_pk_bf16_f32 v224, v80, v81
v_exp_f32 v84, v84
v_exp_f32 v85, v85
v_cvt_pk_bf16_f32 v225, v82, v83
v_exp_f32 v86, v86
ds_read_b64_tr_b16 a[56:57], v3 offset:45056
ds_read_b64_tr_b16 a[58:59], v3 offset:46080
v_exp_f32 v87, v87
v_mfma_f32_32x32x16_bf16 v[128:143], a[236:239], v[220:223], v[128:143]
v_cvt_pk_bf16_f32 v226, v84, v85
v_exp_f32 v88, v88
v_exp_f32 v89, v89
ds_read_b64_tr_b16 a[60:61], v3 offset:61440
ds_read_b64_tr_b16 a[62:63], v3 offset:62464
v_cvt_pk_bf16_f32 v227, v86, v87
v_exp_f32 v90, v90
v_exp_f32 v91, v91
v_cvt_pk_bf16_f32 v228, v88, v89
v_exp_f32 v92, v92
buffer_load_dwordx2 v[38:39], v2, s[12:15], 0 offen offset:384 sc1
v_exp_f32 v93, v93
v_cvt_pk_bf16_f32 v229, v90, v91
v_exp_f32 v94, v94
v_exp_f32 v95, v95
v_cvt_pk_bf16_f32 v230, v92, v93
v_cvt_pk_bf16_f32 v231, v94, v95
v_mfma_f32_32x32x16_bf16 v[128:143], a[240:243], v[224:227], v[128:143]
s_nop 0
v_mfma_f32_32x32x16_bf16 v[128:143], a[244:247], v[228:231], v[128:143]
s_nop 11
v_cmp_gt_f32 vcc, 0x53800000, v136
s_nop 0
s_cmp_eq_u64 vcc, -1
s_cbranch_scc0 L_redo1
L_fin1:
v_rcp_f32 v54, v136
s_add_u32 s89, s89, 0x8000
v_pk_mul_f32 v[128:129], v[128:129], v[54:55] op_sel_hi:[1,0]
v_pk_mul_f32 v[130:131], v[130:131], v[54:55] op_sel_hi:[1,0]
v_pk_mul_f32 v[132:133], v[132:133], v[54:55] op_sel_hi:[1,0]
v_pk_mul_f32 v[134:135], v[134:135], v[54:55] op_sel_hi:[1,0]
v_cvt_pk_bf16_f32 v48, v128, v129
v_cvt_pk_bf16_f32 v49, v130, v131
v_cvt_pk_bf16_f32 v50, v132, v133
v_cvt_pk_bf16_f32 v51, v134, v135
buffer_store_dwordx4 v[48:51], v1, s[12:15], s89 offen sc1
v_lshrrev_b32 v52, 4, v1
v_lshrrev_b32 v53, 5, v52
v_and_b32 v44, 15, v52
v_lshrrev_b32 v45, 4, v52
v_lshrrev_b32 v55, 3, v52
s_lshr_b32 s3, s28, 1
s_lshl_b32 s3, s3, 6
v_and_b32 v42, 0x7ff, v10
v_xor_b32 v42, s3, v42
v_and_b32 v43, 1, v45
v_lshl_add_u32 v13, v43, 11, v42
v_and_b32 v40, 7, v52
v_mov_b32 v41, 0x80000000
v_lshlrev_b32 v10, 2, v52
v_lshlrev_b32 v42, 9, v45
v_lshl_add_u32 v42, v44, 4, v42
v_add_u32 v5, 131072, v42
s_lshl_b32 s3, s28, 8
s_add_u32 s3, s3, 131072
v_add_u32 v9, s3, v10
s_cmp_eq_u32 s28, 0
s_cselect_b32 s3, 0, 0x80000000
v_add_u32 v6, s3, v10
s_lshl4_add_u32 s3, s29, s30
s_lshl_b32 s47, s3, 8
s_add_u32 s47, s47, 0xa00000
s_lshl2_add_u32 s3, s3, s28
s_lshl_b32 s3, s3, 10
s_add_u32 s46, s3, 0x800000
v_accvgpr_read_b32 v42, a124
v_lshlrev_b32 v96, 16, v42
v_and_b32 v97, 0xffff0000, v42
v_accvgpr_read_b32 v42, a125
v_lshlrev_b32 v98, 16, v42
v_and_b32 v99, 0xffff0000, v42
v_accvgpr_read_b32 v42, a126
v_lshlrev_b32 v100, 16, v42
v_and_b32 v101, 0xffff0000, v42
v_accvgpr_read_b32 v42, a127
v_lshlrev_b32 v102, 16, v42
v_and_b32 v103, 0xffff0000, v42
v_accvgpr_read_b32 v42, a128
v_lshlrev_b32 v104, 16, v42
v_and_b32 v105, 0xffff0000, v42
v_accvgpr_read_b32 v42, a129
v_lshlrev_b32 v106, 16, v42
v_and_b32 v107, 0xffff0000, v42
v_accvgpr_read_b32 v42, a130
v_lshlrev_b32 v108, 16, v42
v_and_b32 v109, 0xffff0000, v42
v_accvgpr_read_b32 v42, a131
v_lshlrev_b32 v110, 16, v42
v_and_b32 v111, 0xffff0000, v42
s_waitcnt vmcnt(1)
v_cmp_eq_u64 vcc, s[82:83], v[38:39]
s_nop 0
s_cmp_eq_u32 vcc_lo, 0x3
s_cbranch_scc0 L_spin_oa
L_ok_oa:
s_add_u32 m0, s35, 131072
s_nop 0
buffer_load_dwordx4 v1, s[12:15], s44 offen offset:0 sc1 lds
buffer_load_dwordx4 v1, s[12:15], s44 offen offset:1024 sc1 lds
buffer_load_dwordx4 v1, s[12:15], s44 offen offset:2048 sc1 lds
buffer_load_dwordx4 v1, s[12:15], s44 offen offset:3072 sc1 lds
s_add_u32 m0, s35, 135168
s_add_u32 s44, s44, 4096
buffer_load_dwordx4 v1, s[12:15], s44 offen offset:0 sc1 lds
buffer_load_dwordx4 v1, s[12:15], s44 offen offset:1024 sc1 lds
buffer_load_dwordx4 v1, s[12:15], s44 offen offset:2048 sc1 lds
buffer_load_dwordx4 v1, s[12:15], s44 offen offset:3072 sc1 lds
s_lshl2_add_u32 s39, s31, s28
s_lshl_b32 s3, s39, 13
s_add_u32 s3, s3, 0x40000
v_lshl_add_u32 v42, v52, 10, s3
v_cmp_gt_u32 vcc, 8, v52
s_lshl_b32 s43, s39, 12
s_add_u32 s43, s43, 0xa00000
v_cndmask_b32 v7, v41, v42, vcc
s_lshl_b32 s42, s39, 16
s_and_b32 s3, s2, 4
s_lshl_b32 s3, s3, 12
s_add_u32 s42, s42, s3
s_add_u32 s42, s42, 0x800000
s_mul_i32 s39, s39, 224
s_add_u32 s39, s39, s32
s_mul_i32 s3, s32, 37
s_lshr_b32 s3, s3, 8
s_mul_i32 s3, s3, 21
s_add_u32 s39, s39, s3
s_lshl_b32 s39, s39, 10
s_add_u32 s39, s39, 0xc00000
s_or_b32 s39, s39, s90
v_add_u32 v8, 0x8000, v1
v_accvgpr_read_b32 v59, a134
s_lshl2_add_u32 s3, s30, s28
s_mul_i32 s38, s3, 57344
s_add_u32 s38, s38, 0x1804000
s_lshr_b32 s3, s29, 2
s_lshl_b32 s3, s3, 5
s_mul_i32 s40, s28, 7
s_add_u32 s3, s3, s40
s_and_b32 s40, s29, 3
s_lshl2_add_u32 s3, s3, s40
s_lshl_b32 s3, s3, 9
s_add_u32 s3, s3, 0x80000
v_cmp_gt_u32 vcc, 7, v52
v_lshl_add_u32 v42, v52, 11, s3
s_mul_i32 s3, s28, 8448
v_cndmask_b32 v11, v41, v42, vcc
v_lshlrev_b32 v42, 7, v53
v_xor_b32 v42, v42, v1
v_add_u32 v3, s3, v42
s_lshl_b32 s3, s28, 3
v_add_u32 v42, s3, v55
s_lshl_b32 s3, s29, 16
s_lshl_b32 s40, s30, 7
s_add_u32 s3, s3, s40
v_lshl_add_u32 v12, v42, 10, s3
v_lshl_add_u32 v12, v40, 4, v12
v_lshlrev_b32 v43, 9, v40
v_lshl_add_u32 v43, v42, 4, v43
v_add_u32 v63, 67584, v43
v_bfe_u32 v43, v52, 1, 1
v_mul_u32_u24 v43, 40, v43
v_xor_b32 v42, v42, v43
v_and_b32 v43, 1, v52
v_and_b32 v44, 4, v52
v_lshl_add_u32 v43, v43, 1, v44
v_mul_u32_u24 v43, 1056, v43
v_lshl_add_u32 v4, v42, 4, v43
s_lshl3_add_u32 s3, s29, s28
s_mul_i32 s3, s3, 28672
s_add_u32 s40, s3, 0xc00000
s_add_u32 s41, s3, 0xc1c000
s_and_b32 s3, s28, 0
s_lshl_b32 s3, s3, 13
s_xor_b32 s42, s42, s3
s_lshl_b32 s3, s3, 2
v_xor_b32 v56, s3, v13
v_xor_b32 v57, 32, v56
buffer_load_dwordx2 v[28:29], v59, s[12:15], 0 offen offset:896 sc1
L_hopper2:
v_mov_b32 v48, 0
v_mov_b32 v49, 0
v_mov_b32 v50, 0x3f803f80
v_add_u32 v51, 131072, v10
s_waitcnt vmcnt(5) lgkmcnt(0)
s_barrier
buffer_store_dwordx2 v[34:35], v36, s[12:15], 0 offen offset:512 sc1
ds_read_b128 v[64:67], v5 offset:0
ds_read_b128 v[68:71], v5 offset:256
ds_read_b128 v[72:75], v5 offset:8192
ds_read_b128 v[76:79], v5 offset:8448
ds_read_b128 v[80:83], v5 offset:16384
ds_read_b128 v[84:87], v5 offset:16640
ds_read_b128 v[88:91], v5 offset:24576
s_waitcnt lgkmcnt(5)
v_mfma_f32_16x16x32_bf16 v[96:99], a[0:3], v[64:67], v[96:99]
ds_read_b128 v[92:95], v5 offset:24832
v_mfma_f32_16x16x32_bf16 v[100:103], a[0:3], v[68:71], v[100:103]
ds_read_b128 v[64:67], v5 offset:2048
s_add_u32 m0, s36, 0
s_add_u32 s0, s0, 1
s_and_b32 s0, s0, 7
s_mul_i32 s1, s0, 229376
s_or_b32 s1, s1, s90
buffer_load_dwordx4 v60, s[20:23], s1 offen offset:0  lds
s_waitcnt lgkmcnt(5)
v_mfma_f32_16x16x32_bf16 v[96:99], a[16:19], v[72:75], v[96:99]
ds_read_b128 v[68:71], v5 offset:2304
v_mfma_f32_16x16x32_bf16 v[100:103], a[16:19], v[76:79], v[100:103]
ds_read_b128 v[72:75], v5 offset:10240
s_waitcnt lgkmcnt(5)
v_mfma_f32_16x16x32_bf16 v[96:99], a[32:35], v[80:83], v[96:99]
ds_read_b128 v[76:79], v5 offset:10496
buffer_load_dwordx4 v61, s[20:23], s1 offen offset:1024  lds
v_mfma_f32_16x16x32_bf16 v[100:103], a[32:35], v[84:87], v[100:103]
ds_read_b128 v[80:83], v5 offset:18432
s_waitcnt lgkmcnt(5)
v_mfma_f32_16x16x32_bf16 v[96:99], a[48:51], v[88:91], v[96:99]
ds_read_b128 v[84:87], v5 offset:18688
v_mfma_f32_16x16x32_bf16 v[100:103], a[48:51], v[92:95], v[100:103]
ds_read_b128 v[88:91], v5 offset:26624
s_waitcnt lgkmcnt(5)
v_mfma_f32_16x16x32_bf16 v[96:99], a[4:7], v[64:67], v[96:99]
ds_read_b128 v[92:95], v5 offset:26880
buffer_load_dwordx4 v14, s[4:7], s1 offen offset:2048  lds
v_mfma_f32_16x16x32_bf16 v[100:103], a[4:7], v[68:71], v[100:103]
s_waitcnt vmcnt(5)
s_barrier
ds_read_b128 v[64:67], v5 offset:4096
s_waitcnt lgkmcnt(5)
v_mfma_f32_16x16x32_bf16 v[96:99], a[20:23], v[72:75], v[96:99]
ds_read_b128 v[68:71], v5 offset:4352
v_mfma_f32_16x16x32_bf16 v[100:103], a[20:23], v[76:79], v[100:103]
ds_read_b128 v[72:75], v5 offset:12288
s_waitcnt lgkmcnt(5)
v_mfma_f32_16x16x32_bf16 v[96:99], a[36:39], v[80:83], v[96:99]
ds_read_b128 v[76:79], v5 offset:12544
buffer_load_dwordx4 v15, s[4:7], s1 offen offset:3072  lds
v_mfma_f32_16x16x32_bf16 v[100:103], a[36:39], v[84:87], v[100:103]
ds_read_b128 v[80:83], v5 offset:20480
s_waitcnt lgkmcnt(5)
v_mfma_f32_16x16x32_bf16 v[96:99], a[52:55], v[88:91], v[96:99]
ds_read_b128 v[84:87], v5 offset:20736
v_mfma_f32_16x16x32_bf16 v[100:103], a[52:55], v[92:95], v[100:103]
ds_read_b128 v[88:91], v5 offset:28672
s_waitcnt lgkmcnt(5)
v_mfma_f32_16x16x32_bf16 v[96:99], a[8:11], v[64:67], v[96:99]
ds_read_b128 v[92:95], v5 offset:28928
s_add_u32 m0, s36, 16384
s_add_u32 s0, s0, 1
s_and_b32 s0, s0, 7
s_mul_i32 s1, s0, 229376
s_or_b32 s1, s1, s90
buffer_load_dwordx4 v60, s[20:23], s1 offen offset:0  lds
v_mfma_f32_16x16x32_bf16 v[100:103], a[8:11], v[68:71], v[100:103]
ds_read_b128 v[64:67], v5 offset:6144
s_waitcnt lgkmcnt(5)
v_mfma_f32_16x16x32_bf16 v[96:99], a[24:27], v[72:75], v[96:99]
ds_read_b128 v[68:71], v5 offset:6400
v_mfma_f32_16x16x32_bf16 v[100:103], a[24:27], v[76:79], v[100:103]
ds_read_b128 v[72:75], v5 offset:14336
s_waitcnt lgkmcnt(5)
v_mfma_f32_16x16x32_bf16 v[96:99], a[40:43], v[80:83], v[96:99]
ds_read_b128 v[76:79], v5 offset:14592
buffer_load_dwordx4 v61, s[20:23], s1 offen offset:1024  lds
v_mfma_f32_16x16x32_bf16 v[100:103], a[40:43], v[84:87], v[100:103]
ds_read_b128 v[80:83], v5 offset:22528
s_waitcnt lgkmcnt(5)
v_mfma_f32_16x16x32_bf16 v[96:99], a[56:59], v[88:91], v[96:99]
ds_read_b128 v[84:87], v5 offset:22784
v_mfma_f32_16x16x32_bf16 v[100:103], a[56:59], v[92:95], v[100:103]
ds_read_b128 v[88:91], v5 offset:30720
s_waitcnt lgkmcnt(5)
v_mfma_f32_16x16x32_bf16 v[96:99], a[12:15], v[64:67], v[96:99]
ds_read_b128 v[92:95], v5 offset:30976
buffer_load_dwordx4 v14, s[4:7], s1 offen offset:2048  lds
v_mfma_f32_16x16x32_bf16 v[100:103], a[12:15], v[68:71], v[100:103]
s_waitcnt lgkmcnt(4)
v_mfma_f32_16x16x32_bf16 v[96:99], a[28:31], v[72:75], v[96:99]
v_mfma_f32_16x16x32_bf16 v[100:103], a[28:31], v[76:79], v[100:103]
s_waitcnt lgkmcnt(2)
v_mfma_f32_16x16x32_bf16 v[96:99], a[44:47], v[80:83], v[96:99]
buffer_load_dwordx4 v15, s[4:7], s1 offen offset:3072  lds
v_mfma_f32_16x16x32_bf16 v[100:103], a[44:47], v[84:87], v[100:103]
s_waitcnt lgkmcnt(0)
v_mfma_f32_16x16x32_bf16 v[96:99], a[60:63], v[88:91], v[96:99]
v_mfma_f32_16x16x32_bf16 v[100:103], a[60:63], v[92:95], v[100:103]
buffer_load_dwordx2 v[38:39], v2, s[12:15], 0 offen offset:512 sc1
s_nop 5
v_cvt_pk_bf16_f32 v20, v96, v97
v_cvt_pk_bf16_f32 v22, v100, v101
v_cvt_pk_bf16_f32 v21, v98, v99
v_cvt_pk_bf16_f32 v23, v102, v103
v_permlane16_swap_b32 v20, v22
s_nop 0
v_permlane16_swap_b32 v21, v23
buffer_store_dwordx4 v[20:23], v1, s[12:15], s46 offen sc1
v_dot2c_f32_bf16 v48, v20, v50
v_dot2c_f32_bf16 v49, v20, v20
v_dot2c_f32_bf16 v48, v21, v50
v_dot2c_f32_bf16 v49, v21, v21
v_dot2c_f32_bf16 v48, v22, v50
v_dot2c_f32_bf16 v49, v22, v22
v_dot2c_f32_bf16 v48, v23, v50
v_dot2c_f32_bf16 v49, v23, v23
s_nop 2
v_permlane32_swap_b32 v48, v49
v_add_f32 v48, v48, v49
ds_write_b32 v9, v48
s_waitcnt lgkmcnt(0)
s_barrier
ds_read2st64_b32 v[48:49], v51 offset0:0 offset1:1
ds_read2st64_b32 v[50:51], v51 offset0:2 offset1:3
s_waitcnt lgkmcnt(1)
v_add_f32 v48, v48, v49
s_waitcnt lgkmcnt(0)
v_add_f32 v50, v50, v51
v_add_f32 v48, v48, v50
buffer_store_dword v48, v6, s[12:15], s47 offen offset:0 sc1
s_add_u32 m0, s36, 32768
s_add_u32 s0, s0, 1
s_and_b32 s0, s0, 7
s_mul_i32 s1, s0, 229376
s_or_b32 s1, s1, s90
buffer_load_dwordx4 v60, s[20:23], s1 offen offset:0  lds
buffer_load_dwordx4 v61, s[20:23], s1 offen offset:1024  lds
buffer_load_dwordx4 v14, s[4:7], s1 offen offset:2048  lds
buffer_load_dwordx4 v15, s[4:7], s1 offen offset:3072  lds
s_lshl_b32 s3, s28, 5
s_or_b32 s3, s3, 0x10000
v_xor_b32 v58, s3, v13
ds_read_b64_tr_b16 v[64:65], v58 offset:0
ds_read_b64_tr_b16 v[66:67], v58 offset:512
ds_read_b64_tr_b16 v[68:69], v58 offset:4096
ds_read_b64_tr_b16 v[70:71], v58 offset:4608
ds_read_b64_tr_b16 v[72:73], v58 offset:8192
ds_read_b64_tr_b16 v[74:75], v58 offset:8704
ds_read_b64_tr_b16 v[76:77], v58 offset:12288
ds_read_b64_tr_b16 v[78:79], v58 offset:12800
ds_read_b64_tr_b16 v[80:81], v58 offset:16384
ds_read_b64_tr_b16 v[82:83], v58 offset:16896
ds_read_b64_tr_b16 v[84:85], v58 offset:20480
ds_read_b64_tr_b16 v[86:87], v58 offset:20992
ds_read_b64_tr_b16 v[88:89], v58 offset:24576
ds_read_b64_tr_b16 v[90:91], v58 offset:25088
s_waitcnt lgkmcnt(10)
v_mfma_f32_16x16x32_bf16 v[112:115], v[16:19], v[64:67], 0
ds_read_b64_tr_b16 v[92:93], v58 offset:28672
ds_read_b64_tr_b16 v[94:95], v58 offset:29184
v_mfma_f32_16x16x32_bf16 v[112:115], v[16:19], v[68:71], v[112:115]
ds_read_b64_tr_b16 v[64:65], v58 offset:32768
ds_read_b64_tr_b16 v[66:67], v58 offset:33280
s_waitcnt lgkmcnt(10)
v_mfma_f32_16x16x32_bf16 v[112:115], v[16:19], v[72:75], v[112:115]
ds_read_b64_tr_b16 v[68:69], v58 offset:36864
ds_read_b64_tr_b16 v[70:71], v58 offset:37376
v_mfma_f32_16x16x32_bf16 v[112:115], v[16:19], v[76:79], v[112:115]
ds_read_b64_tr_b16 v[72:73], v58 offset:40960
ds_read_b64_tr_b16 v[74:75], v58 offset:41472
s_waitcnt lgkmcnt(10)
v_mfma_f32_16x16x32_bf16 v[112:115], v[16:19], v[80:83], v[112:115]
ds_read_b64_tr_b16 v[76:77], v58 offset:45056
ds_read_b64_tr_b16 v[78:79], v58 offset:45568
v_mfma_f32_16x16x32_bf16 v[112:115], v[16:19], v[84:87], v[112:115]
ds_read_b64_tr_b16 v[80:81], v58 offset:49152
ds_read_b64_tr_b16 v[82:83], v58 offset:49664
s_waitcnt lgkmcnt(10)
v_mfma_f32_16x16x32_bf16 v[112:115], v[16:19], v[88:91], v[112:115]
ds_read_b64_tr_b16 v[84:85], v58 offset:53248
ds_read_b64_tr_b16 v[86:87], v58 offset:53760
v_mfma_f32_16x16x32_bf16 v[112:115], v[16:19], v[92:95], v[112:115]
ds_read_b64_tr_b16 v[88:89], v58 offset:57344
ds_read_b64_tr_b16 v[90:91], v58 offset:57856
s_waitcnt lgkmcnt(10)
v_mfma_f32_16x16x32_bf16 v[112:115], v[16:19], v[64:67], v[112:115]
ds_read_b64_tr_b16 v[92:93], v58 offset:61440
ds_read_b64_tr_b16 v[94:95], v58 offset:61952
v_mfma_f32_16x16x32_bf16 v[112:115], v[16:19], v[68:71], v[112:115]
s_waitcnt lgkmcnt(8)
v_mfma_f32_16x16x32_bf16 v[112:115], v[16:19], v[72:75], v[112:115]
v_mfma_f32_16x16x32_bf16 v[112:115], v[16:19], v[76:79], v[112:115]
s_waitcnt lgkmcnt(4)
v_mfma_f32_16x16x32_bf16 v[112:115], v[16:19], v[80:83], v[112:115]
v_mfma_f32_16x16x32_bf16 v[112:115], v[16:19], v[84:87], v[112:115]
s_waitcnt lgkmcnt(0)
v_mfma_f32_16x16x32_bf16 v[112:115], v[16:19], v[88:91], v[112:115]
v_mfma_f32_16x16x32_bf16 v[112:115], v[16:19], v[92:95], v[112:115]
s_waitcnt vmcnt(6)
v_cmp_eq_u64 vcc, s[82:83], v[38:39]
s_nop 0
s_cmp_eq_u32 vcc_lo, 0x3
s_cbranch_scc0 L_spin_ob
L_ok_ob:
s_add_u32 m0, s35, 131072
s_add_u32 s44, s44, 28672
buffer_load_dwordx4 v1, s[12:15], s44 offen offset:0 sc1 lds
buffer_load_dwordx4 v1, s[12:15], s44 offen offset:1024 sc1 lds
buffer_load_dwordx4 v1, s[12:15], s44 offen offset:2048 sc1 lds
buffer_load_dwordx4 v1, s[12:15], s44 offen offset:3072 sc1 lds
s_add_u32 m0, s35, 135168
s_add_u32 s44, s44, 4096
buffer_load_dwordx4 v1, s[12:15], s44 offen offset:0 sc1 lds
buffer_load_dwordx4 v1, s[12:15], s44 offen offset:1024 sc1 lds
buffer_load_dwordx4 v1, s[12:15], s44 offen offset:2048 sc1 lds
buffer_load_dwordx4 v1, s[12:15], s44 offen offset:3072 sc1 lds
s_waitcnt vmcnt(12)
s_barrier
buffer_store_dwordx2 v[34:35], v36, s[12:15], 0 offen offset:640 sc1
s_add_u32 m0, s36, 49152
s_add_u32 s0, s0, 1
s_and_b32 s0, s0, 7
s_mul_i32 s1, s0, 229376
s_or_b32 s1, s1, s90
buffer_load_dwordx4 v60, s[20:23], s1 offen offset:0  lds
buffer_load_dwordx4 v61, s[20:23], s1 offen offset:1024  lds
buffer_load_dwordx4 v14, s[4:7], s1 offen offset:2048  lds
buffer_load_dwordx4 v15, s[4:7], s1 offen offset:3072  lds
v_cmp_eq_u64 vcc, s[82:83], v[28:29]
s_nop 0
s_cmp_eq_u32 vcc_lo, 0x7f
s_cbranch_scc0 L_spin_d
L_ok_d:
buffer_load_dwordx4 a[64:67], v1, s[12:15], s38 offen offset:0 sc1
buffer_load_dwordx4 a[68:71], v1, s[12:15], s38 offen offset:1024 sc1
buffer_load_dwordx4 a[72:75], v1, s[12:15], s38 offen offset:2048 sc1
buffer_load_dwordx4 a[76:79], v1, s[12:15], s38 offen offset:3072 sc1
s_add_u32 s38, s38, 4096
v_mov_b32 v48, 0
v_mov_b32 v49, 0
v_mov_b32 v50, 0x3f803f80
v_add_u32 v51, 131072, v10
s_add_u32 s46, s46, 0x8000
s_waitcnt vmcnt(13)
s_barrier
ds_read_b128 v[64:67], v5 offset:0
ds_read_b128 v[68:71], v5 offset:256
ds_read_b128 v[72:75], v5 offset:8192
ds_read_b128 v[76:79], v5 offset:8448
ds_read_b128 v[80:83], v5 offset:16384
ds_read_b128 v[84:87], v5 offset:16640
ds_read_b128 v[88:91], v5 offset:24576
s_waitcnt lgkmcnt(5)
v_mfma_f32_16x16x32_bf16 v[104:107], a[0:3], v[64:67], v[104:107]
ds_read_b128 v[92:95], v5 offset:24832
v_mfma_f32_16x16x32_bf16 v[108:111], a[0:3], v[68:71], v[108:111]
ds_read_b128 v[64:67], v5 offset:2048
buffer_load_dwordx4 a[80:83], v1, s[12:15], s38 offen offset:0 sc1
s_waitcnt lgkmcnt(5)
v_mfma_f32_16x16x32_bf16 v[104:107], a[16:19], v[72:75], v[104:107]
ds_read_b128 v[68:71], v5 offset:2304
v_mfma_f32_16x16x32_bf16 v[108:111], a[16:19], v[76:79], v[108:111]
ds_read_b128 v[72:75], v5 offset:10240
s_waitcnt lgkmcnt(5)
v_mfma_f32_16x16x32_bf16 v[104:107], a[32:35], v[80:83], v[104:107]
ds_read_b128 v[76:79], v5 offset:10496
buffer_load_dwordx4 a[84:87], v1, s[12:15], s38 offen offset:1024 sc1
v_mfma_f32_16x16x32_bf16 v[108:111], a[32:35], v[84:87], v[108:111]
ds_read_b128 v[80:83], v5 offset:18432
s_waitcnt lgkmcnt(5)
v_mfma_f32_16x16x32_bf16 v[104:107], a[48:51], v[88:91], v[104:107]
ds_read_b128 v[84:87], v5 offset:18688
v_mfma_f32_16x16x32_bf16 v[108:111], a[48:51], v[92:95], v[108:111]
ds_read_b128 v[88:91], v5 offset:26624
s_waitcnt lgkmcnt(5)
v_mfma_f32_16x16x32_bf16 v[104:107], a[4:7], v[64:67], v[104:107]
ds_read_b128 v[92:95], v5 offset:26880
buffer_load_dwordx4 a[88:91], v1, s[12:15], s38 offen offset:2048 sc1
v_mfma_f32_16x16x32_bf16 v[108:111], a[4:7], v[68:71], v[108:111]
s_waitcnt vmcnt(12)
s_barrier
ds_read_b128 v[64:67], v5 offset:4096
s_waitcnt lgkmcnt(5)
v_mfma_f32_16x16x32_bf16 v[104:107], a[20:23], v[72:75], v[104:107]
ds_read_b128 v[68:71], v5 offset:4352
v_mfma_f32_16x16x32_bf16 v[108:111], a[20:23], v[76:79], v[108:111]
ds_read_b128 v[72:75], v5 offset:12288
s_waitcnt lgkmcnt(5)
v_mfma_f32_16x16x32_bf16 v[104:107], a[36:39], v[80:83], v[104:107]
ds_read_b128 v[76:79], v5 offset:12544
buffer_load_dwordx4 a[92:95], v1, s[12:15], s38 offen offset:3072 sc1
s_add_u32 s38, s38, 4096
v_mfma_f32_16x16x32_bf16 v[108:111], a[36:39], v[84:87], v[108:111]
ds_read_b128 v[80:83], v5 offset:20480
s_waitcnt lgkmcnt(5)
v_mfma_f32_16x16x32_bf16 v[104:107], a[52:55], v[88:91], v[104:107]
ds_read_b128 v[84:87], v5 offset:20736
v_mfma_f32_16x16x32_bf16 v[108:111], a[52:55], v[92:95], v[108:111]
ds_read_b128 v[88:91], v5 offset:28672
s_waitcnt lgkmcnt(5)
v_mfma_f32_16x16x32_bf16 v[104:107], a[8:11], v[64:67], v[104:107]
ds_read_b128 v[92:95], v5 offset:28928
buffer_load_dwordx4 a[96:99], v1, s[12:15], s38 offen offset:0 sc1
v_mfma_f32_16x16x32_bf16 v[108:111], a[8:11], v[68:71], v[108:111]
ds_read_b128 v[64:67], v5 offset:6144
s_waitcnt lgkmcnt(5)
v_mfma_f32_16x16x32_bf16 v[104:107], a[24:27], v[72:75], v[104:107]
ds_read_b128 v[68:71], v5 offset:6400
v_mfma_f32_16x16x32_bf16 v[108:111], a[24:27], v[76:79], v[108:111]
ds_read_b128 v[72:75], v5 offset:14336
s_waitcnt lgkmcnt(5)
v_mfma_f32_16x16x32_bf16 v[104:107], a[40:43], v[80:83], v[104:107]
ds_read_b128 v[76:79], v5 offset:14592
buffer_load_dwordx4 a[100:103], v1, s[12:15], s38 offen offset:1024 sc1
v_mfma_f32_16x16x32_bf16 v[108:111], a[40:43], v[84:87], v[108:111]
ds_read_b128 v[80:83], v5 offset:22528
s_waitcnt lgkmcnt(5)
v_mfma_f32_16x16x32_bf16 v[104:107], a[56:59], v[88:91], v[104:107]
ds_read_b128 v[84:87], v5 offset:22784
v_mfma_f32_16x16x32_bf16 v[108:111], a[56:59], v[92:95], v[108:111]
ds_read_b128 v[88:91], v5 offset:30720
s_waitcnt lgkmcnt(5)
v_mfma_f32_16x16x32_bf16 v[104:107], a[12:15], v[64:67], v[104:107]
ds_read_b128 v[92:95], v5 offset:30976
buffer_load_dwordx4 a[104:107], v1, s[12:15], s38 offen offset:2048 sc1
v_mfma_f32_16x16x32_bf16 v[108:111], a[12:15], v[68:71], v[108:111]
s_waitcnt lgkmcnt(4)
v_mfma_f32_16x16x32_bf16 v[104:107], a[28:31], v[72:75], v[104:107]
v_mfma_f32_16x16x32_bf16 v[108:111], a[28:31], v[76:79], v[108:111]
s_waitcnt lgkmcnt(2)
v_mfma_f32_16x16x32_bf16 v[104:107], a[44:47], v[80:83], v[104:107]
buffer_load_dwordx4 a[108:111], v1, s[12:15], s38 offen offset:3072 sc1
s_add_u32 s38, s38, 4096
v_mfma_f32_16x16x32_bf16 v[108:111], a[44:47], v[84:87], v[108:111]
s_waitcnt lgkmcnt(0)
v_mfma_f32_16x16x32_bf16 v[104:107], a[60:63], v[88:91], v[104:107]
v_mfma_f32_16x16x32_bf16 v[108:111], a[60:63], v[92:95], v[108:111]
buffer_load_dwordx2 v[38:39], v7, s[12:15], 0 offen offset:640 sc1
s_nop 5
v_cvt_pk_bf16_f32 v24, v104, v105
v_cvt_pk_bf16_f32 v26, v108, v109
v_cvt_pk_bf16_f32 v25, v106, v107
v_cvt_pk_bf16_f32 v27, v110, v111
v_permlane16_swap_b32 v24, v26
s_nop 0
v_permlane16_swap_b32 v25, v27
buffer_store_dwordx4 v[24:27], v1, s[12:15], s46 offen sc1
v_dot2c_f32_bf16 v48, v24, v50
v_dot2c_f32_bf16 v49, v24, v24
v_dot2c_f32_bf16 v48, v25, v50
v_dot2c_f32_bf16 v49, v25, v25
v_dot2c_f32_bf16 v48, v26, v50
v_dot2c_f32_bf16 v49, v26, v26
v_dot2c_f32_bf16 v48, v27, v50
v_dot2c_f32_bf16 v49, v27, v27
s_nop 2
v_permlane32_swap_b32 v48, v49
v_add_f32 v48, v48, v49
ds_write_b32 v9, v48
s_waitcnt vmcnt(14) lgkmcnt(0)
s_barrier
ds_read2st64_b32 v[48:49], v51 offset0:0 offset1:1
ds_read2st64_b32 v[50:51], v51 offset0:2 offset1:3
s_waitcnt lgkmcnt(1)
v_add_f32 v48, v48, v49
s_waitcnt lgkmcnt(0)
v_add_f32 v50, v50, v51
v_add_f32 v48, v48, v50
buffer_store_dword v48, v6, s[12:15], s47 offen offset:2048 sc1
buffer_load_dwordx4 a[112:115], v1, s[12:15], s38 offen offset:0 sc1
buffer_load_dwordx4 a[116:119], v1, s[12:15], s38 offen offset:1024 sc1
buffer_load_dwordx4 a[120:123], v1, s[12:15], s38 offen offset:2048 sc1
buffer_load_dwordx4 a[124:127], v1, s[12:15], s38 offen offset:3072 sc1
s_add_u32 s38, s38, 4096
v_xor_b32 v58, 0x10000, v58
ds_read_b64_tr_b16 v[64:65], v58 offset:0
ds_read_b64_tr_b16 v[66:67], v58 offset:512
ds_read_b64_tr_b16 v[68:69], v58 offset:4096
ds_read_b64_tr_b16 v[70:71], v58 offset:4608
ds_read_b64_tr_b16 v[72:73], v58 offset:8192
ds_read_b64_tr_b16 v[74:75], v58 offset:8704
ds_read_b64_tr_b16 v[76:77], v58 offset:12288
ds_read_b64_tr_b16 v[78:79], v58 offset:12800
ds_read_b64_tr_b16 v[80:81], v58 offset:16384
ds_read_b64_tr_b16 v[82:83], v58 offset:16896
ds_read_b64_tr_b16 v[84:85], v58 offset:20480
ds_read_b64_tr_b16 v[86:87], v58 offset:20992
ds_read_b64_tr_b16 v[88:89], v58 offset:24576
ds_read_b64_tr_b16 v[90:91], v58 offset:25088
s_waitcnt lgkmcnt(10)
v_mfma_f32_16x16x32_bf16 v[112:115], v[16:19], v[64:67], v[112:115]
ds_read_b64_tr_b16 v[92:93], v58 offset:28672
ds_read_b64_tr_b16 v[94:95], v58 offset:29184
v_mfma_f32_16x16x32_bf16 v[112:115], v[16:19], v[68:71], v[112:115]
ds_read_b64_tr_b16 v[64:65], v58 offset:32768
ds_read_b64_tr_b16 v[66:67], v58 offset:33280
s_waitcnt lgkmcnt(10)
v_mfma_f32_16x16x32_bf16 v[112:115], v[16:19], v[72:75], v[112:115]
ds_read_b64_tr_b16 v[68:69], v58 offset:36864
ds_read_b64_tr_b16 v[70:71], v58 offset:37376
v_mfma_f32_16x16x32_bf16 v[112:115], v[16:19], v[76:79], v[112:115]
ds_read_b64_tr_b16 v[72:73], v58 offset:40960
ds_read_b64_tr_b16 v[74:75], v58 offset:41472
s_waitcnt lgkmcnt(10)
v_mfma_f32_16x16x32_bf16 v[112:115], v[16:19], v[80:83], v[112:115]
ds_read_b64_tr_b16 v[76:77], v58 offset:45056
ds_read_b64_tr_b16 v[78:79], v58 offset:45568
v_mfma_f32_16x16x32_bf16 v[112:115], v[16:19], v[84:87], v[112:115]
ds_read_b64_tr_b16 v[80:81], v58 offset:49152
ds_read_b64_tr_b16 v[82:83], v58 offset:49664
s_waitcnt lgkmcnt(10)
v_mfma_f32_16x16x32_bf16 v[112:115], v[16:19], v[88:91], v[112:115]
ds_read_b64_tr_b16 v[84:85], v58 offset:53248
ds_read_b64_tr_b16 v[86:87], v58 offset:53760
v_mfma_f32_16x16x32_bf16 v[112:115], v[16:19], v[92:95], v[112:115]
ds_read_b64_tr_b16 v[88:89], v58 offset:57344
ds_read_b64_tr_b16 v[90:91], v58 offset:57856
s_waitcnt lgkmcnt(10)
v_mfma_f32_16x16x32_bf16 v[112:115], v[16:19], v[64:67], v[112:115]
ds_read_b64_tr_b16 v[92:93], v58 offset:61440
ds_read_b64_tr_b16 v[94:95], v58 offset:61952
v_mfma_f32_16x16x32_bf16 v[112:115], v[16:19], v[68:71], v[112:115]
s_waitcnt lgkmcnt(8)
v_mfma_f32_16x16x32_bf16 v[112:115], v[16:19], v[72:75], v[112:115]
v_mfma_f32_16x16x32_bf16 v[112:115], v[16:19], v[76:79], v[112:115]
s_waitcnt lgkmcnt(4)
v_mfma_f32_16x16x32_bf16 v[112:115], v[16:19], v[80:83], v[112:115]
v_mfma_f32_16x16x32_bf16 v[112:115], v[16:19], v[84:87], v[112:115]
s_waitcnt lgkmcnt(0)
v_mfma_f32_16x16x32_bf16 v[112:115], v[16:19], v[88:91], v[112:115]
v_mfma_f32_16x16x32_bf16 v[112:115], v[16:19], v[92:95], v[112:115]
s_waitcnt vmcnt(6)
v_cmp_eq_u64 vcc, s[82:83], v[38:39]
s_nop 0
s_cmp_eq_u32 vcc_lo, 0xff
s_cbranch_scc0 L_spin_h
L_ok_h:
buffer_load_dwordx4 v[128:131], v1, s[12:15], s42 offen offset:0 sc1
buffer_load_dwordx4 v[132:135], v1, s[12:15], s42 offen offset:1024 sc1
buffer_load_dwordx4 v[136:139], v1, s[12:15], s42 offen offset:2048 sc1
buffer_load_dwordx4 v[140:143], v1, s[12:15], s42 offen offset:3072 sc1
s_xor_b32 s42, s42, 0x1000
buffer_load_dwordx4 v[144:147], v1, s[12:15], s42 offen offset:0 sc1
buffer_load_dwordx4 v[148:151], v1, s[12:15], s42 offen offset:1024 sc1
buffer_load_dwordx4 v[152:155], v1, s[12:15], s42 offen offset:2048 sc1
buffer_load_dwordx4 v[156:159], v1, s[12:15], s42 offen offset:3072 sc1
s_xor_b32 s42, s42, 0x3000
buffer_load_dwordx4 v[160:163], v1, s[12:15], s42 offen offset:0 sc1
buffer_load_dwordx4 v[164:167], v1, s[12:15], s42 offen offset:1024 sc1
buffer_load_dwordx4 v[168:171], v1, s[12:15], s42 offen offset:2048 sc1
buffer_load_dwordx4 v[172:175], v1, s[12:15], s42 offen offset:3072 sc1
s_xor_b32 s42, s42, 0x1000
s_cmp_lg_u32 s90, 0
s_cbranch_scc1 L_idle
v_xor_b32 v2, 64, v56
v_xor_b32 v5, 64, v57
ds_read_b64_tr_b16 a[224:225], v56 offset:0
ds_read_b64_tr_b16 a[226:227], v56 offset:512
ds_read_b64_tr_b16 a[228:229], v57 offset:0
ds_read_b64_tr_b16 a[230:231], v57 offset:512
ds_read_b64_tr_b16 a[232:233], v56 offset:4096
ds_read_b64_tr_b16 a[234:235], v56 offset:4608
ds_read_b64_tr_b16 a[236:237], v57 offset:4096
ds_read_b64_tr_b16 a[238:239], v57 offset:4608
ds_read_b64_tr_b16 a[240:241], v56 offset:8192
ds_read_b64_tr_b16 a[242:243], v56 offset:8704
ds_read_b64_tr_b16 a[244:245], v57 offset:8192
ds_read_b64_tr_b16 a[246:247], v57 offset:8704
ds_read_b64_tr_b16 a[248:249], v56 offset:12288
ds_read_b64_tr_b16 a[250:251], v56 offset:12800
ds_write_b32 v9, v112 offset:4096
v_add_u32 v45, 135168, v10
s_waitcnt lgkmcnt(7)
s_waitcnt vmcnt(11)
v_mfma_f32_32x32x16_bf16 v[64:79], a[224:227], v[128:131], 0
ds_read_b64_tr_b16 a[252:253], v57 offset:12288
ds_read_b64_tr_b16 a[254:255], v57 offset:12800
buffer_load_dwordx4 v[176:179], v1, s[12:15], s42 offen offset:0 sc1
v_mfma_f32_32x32x16_bf16 v[80:95], a[228:231], v[128:131], 0
ds_read_b64_tr_b16 a[224:225], v56 offset:16384
ds_read_b64_tr_b16 a[226:227], v56 offset:16896
s_waitcnt vmcnt(11)
v_mfma_f32_32x32x16_bf16 v[64:79], a[232:235], v[132:135], v[64:79]
ds_read_b64_tr_b16 a[228:229], v57 offset:16384
ds_read_b64_tr_b16 a[230:231], v57 offset:16896
buffer_load_dwordx4 v[180:183], v1, s[12:15], s42 offen offset:1024 sc1
v_mfma_f32_32x32x16_bf16 v[80:95], a[236:239], v[132:135], v[80:95]
ds_read_b64_tr_b16 a[232:233], v56 offset:20480
ds_read_b64_tr_b16 a[234:235], v56 offset:20992
s_waitcnt lgkmcnt(6)
s_waitcnt vmcnt(11)
v_mfma_f32_32x32x16_bf16 v[64:79], a[240:243], v[136:139], v[64:79]
ds_read_b64_tr_b16 a[236:237], v57 offset:20480
ds_read_b64_tr_b16 a[238:239], v57 offset:20992
buffer_load_dwordx4 v[184:187], v1, s[12:15], s42 offen offset:2048 sc1
v_mfma_f32_32x32x16_bf16 v[80:95], a[244:247], v[136:139], v[80:95]
ds_read_b64_tr_b16 a[240:241], v56 offset:24576
ds_read_b64_tr_b16 a[242:243], v56 offset:25088
s_waitcnt vmcnt(11)
v_mfma_f32_32x32x16_bf16 v[64:79], a[248:251], v[140:143], v[64:79]
ds_read_b64_tr_b16 a[244:245], v57 offset:24576
ds_read_b64_tr_b16 a[246:247], v57 offset:25088
buffer_load_dwordx4 v[188:191], v1, s[12:15], s42 offen offset:3072 sc1
s_xor_b32 s42, s42, 0x7000
v_mfma_f32_32x32x16_bf16 v[80:95], a[252:255], v[140:143], v[80:95]
ds_read_b64_tr_b16 a[248:249], v56 offset:28672
ds_read_b64_tr_b16 a[250:251], v56 offset:29184
s_waitcnt lgkmcnt(6)
s_waitcnt vmcnt(11)
v_mfma_f32_32x32x16_bf16 v[64:79], a[224:227], v[144:147], v[64:79]
ds_read_b64_tr_b16 a[252:253], v57 offset:28672
ds_read_b64_tr_b16 a[254:255], v57 offset:29184
buffer_load_dwordx4 v[192:195], v1, s[12:15], s42 offen offset:0 sc1
v_mfma_f32_32x32x16_bf16 v[80:95], a[228:231], v[144:147], v[80:95]
ds_read_b64_tr_b16 a[224:225], v56 offset:32768
ds_read_b64_tr_b16 a[226:227], v56 offset:33280
s_waitcnt vmcnt(11)
v_mfma_f32_32x32x16_bf16 v[64:79], a[232:235], v[148:151], v[64:79]
ds_read_b64_tr_b16 a[228:229], v57 offset:32768
ds_read_b64_tr_b16 a[230:231], v57 offset:33280
buffer_load_dwordx4 v[196:199], v1, s[12:15], s42 offen offset:1024 sc1
v_mfma_f32_32x32x16_bf16 v[80:95], a[236:239], v[148:151], v[80:95]
ds_read_b64_tr_b16 a[232:233], v56 offset:36864
ds_read_b64_tr_b16 a[234:235], v56 offset:37376
s_waitcnt lgkmcnt(6)
s_waitcnt vmcnt(11)
v_mfma_f32_32x32x16_bf16 v[64:79], a[240:243], v[152:155], v[64:79]
ds_read_b64_tr_b16 a[236:237], v57 offset:36864
ds_read_b64_tr_b16 a[238:239], v57 offset:37376
buffer_load_dwordx4 v[200:203], v1, s[12:15], s42 offen offset:2048 sc1
v_mfma_f32_32x32x16_bf16 v[80:95], a[244:247], v[152:155], v[80:95]
ds_read_b64_tr_b16 a[240:241], v56 offset:40960
ds_read_b64_tr_b16 a[242:243], v56 offset:41472
s_waitcnt vmcnt(11)
v_mfma_f32_32x32x16_bf16 v[64:79], a[248:251], v[156:159], v[64:79]
ds_read_b64_tr_b16 a[244:245], v57 offset:40960
ds_read_b64_tr_b16 a[246:247], v57 offset:41472
buffer_load_dwordx4 v[204:207], v1, s[12:15], s42 offen offset:3072 sc1
s_xor_b32 s42, s42, 0x1000
v_mfma_f32_32x32x16_bf16 v[80:95], a[252:255], v[156:159], v[80:95]
ds_read_b64_tr_b16 a[248:249], v56 offset:45056
ds_read_b64_tr_b16 a[250:251], v56 offset:45568
s_waitcnt lgkmcnt(6)
s_waitcnt vmcnt(11)
v_mfma_f32_32x32x16_bf16 v[64:79], a[224:227], v[160:163], v[64:79]
ds_read_b64_tr_b16 a[252:253], v57 offset:45056
ds_read_b64_tr_b16 a[254:255], v57 offset:45568
buffer_load_dwordx4 v[208:211], v1, s[12:15], s42 offen offset:0 sc1
buffer_load_dword v48, v10, s[12:15], s43 offen offset:0 sc1
v_mfma_f32_32x32x16_bf16 v[80:95], a[228:231], v[160:163], v[80:95]
ds_read_b64_tr_b16 a[224:225], v56 offset:49152
ds_read_b64_tr_b16 a[226:227], v56 offset:49664
s_barrier
buffer_store_dwordx2 v[34:35], v36, s[12:15], 0 offen offset:768 sc1
s_waitcnt vmcnt(13)
v_mfma_f32_32x32x16_bf16 v[64:79], a[232:235], v[164:167], v[64:79]
ds_read_b64_tr_b16 a[228:229], v57 offset:49152
ds_read_b64_tr_b16 a[230:231], v57 offset:49664
buffer_load_dwordx4 v[212:215], v1, s[12:15], s42 offen offset:1024 sc1
buffer_load_dword v49, v10, s[12:15], s43 offen offset:256 sc1
ds_read2st64_b32 v[40:41], v45 offset0:0 offset1:1
ds_read2st64_b32 v[42:43], v45 offset0:2 offset1:3
v_mfma_f32_32x32x16_bf16 v[80:95], a[236:239], v[164:167], v[80:95]
ds_read_b64_tr_b16 a[232:233], v56 offset:53248
ds_read_b64_tr_b16 a[234:235], v56 offset:53760
s_waitcnt lgkmcnt(8)
s_waitcnt vmcnt(14)
v_mfma_f32_32x32x16_bf16 v[64:79], a[240:243], v[168:171], v[64:79]
ds_read_b64_tr_b16 a[236:237], v57 offset:53248
ds_read_b64_tr_b16 a[238:239], v57 offset:53760
buffer_load_dwordx4 v[216:219], v1, s[12:15], s42 offen offset:2048 sc1
buffer_load_dword v50, v10, s[12:15], s43 offen offset:512 sc1
v_mfma_f32_32x32x16_bf16 v[80:95], a[244:247], v[168:171], v[80:95]
ds_read_b64_tr_b16 a[240:241], v56 offset:57344
ds_read_b64_tr_b16 a[242:243], v56 offset:57856
s_waitcnt vmcnt(15)
v_mfma_f32_32x32x16_bf16 v[64:79], a[248:251], v[172:175], v[64:79]
ds_read_b64_tr_b16 a[244:245], v57 offset:57344
ds_read_b64_tr_b16 a[246:247], v57 offset:57856
buffer_load_dwordx4 v[220:223], v1, s[12:15], s42 offen offset:3072 sc1
s_xor_b32 s42, s42, 0x3000
buffer_load_dword v51, v10, s[12:15], s43 offen offset:768 sc1
s_waitcnt lgkmcnt(9)
v_cvt_pk_bf16_f32 v16, v40, v40
v_and_b32 v44, 0xffff0000, v16
v_mfma_f32_32x32x16_bf16 v[80:95], a[252:255], v[172:175], v[80:95]
ds_read_b64_tr_b16 a[248:249], v56 offset:61440
ds_read_b64_tr_b16 a[250:251], v56 offset:61952
v_xor_b32 v56, 0x10000, v56
v_sub_f32 v44, v40, v44
v_cvt_pk_bf16_f32 v17, v44, v44
s_waitcnt lgkmcnt(6)
s_waitcnt vmcnt(16)
v_mfma_f32_32x32x16_bf16 v[64:79], a[224:227], v[176:179], v[64:79]
ds_read_b64_tr_b16 a[252:253], v57 offset:61440
ds_read_b64_tr_b16 a[254:255], v57 offset:61952
v_xor_b32 v57, 0x10000, v57
buffer_load_dwordx4 v[224:227], v1, s[12:15], s42 offen offset:0 sc1
buffer_load_dword v52, v10, s[12:15], s43 offen offset:1024 sc1
v_cvt_pk_bf16_f32 v18, v41, v41
v_and_b32 v44, 0xffff0000, v18
v_mfma_f32_32x32x16_bf16 v[80:95], a[228:231], v[176:179], v[80:95]
ds_read_b64_tr_b16 a[224:225], v56 offset:0
ds_read_b64_tr_b16 a[226:227], v56 offset:512
v_sub_f32 v44, v41, v44
v_cvt_pk_bf16_f32 v19, v44, v44
s_waitcnt vmcnt(17)
v_mfma_f32_32x32x16_bf16 v[64:79], a[232:235], v[180:183], v[64:79]
ds_read_b64_tr_b16 a[228:229], v57 offset:0
ds_read_b64_tr_b16 a[230:231], v57 offset:512
buffer_load_dwordx4 v[228:231], v1, s[12:15], s42 offen offset:1024 sc1
buffer_load_dword v53, v10, s[12:15], s43 offen offset:1280 sc1
v_cvt_pk_bf16_f32 v58, v42, v42
v_and_b32 v44, 0xffff0000, v58
v_mfma_f32_32x32x16_bf16 v[80:95], a[236:239], v[180:183], v[80:95]
ds_read_b64_tr_b16 a[232:233], v56 offset:4096
ds_read_b64_tr_b16 a[234:235], v56 offset:4608
v_sub_f32 v44, v42, v44
v_cvt_pk_bf16_f32 v59, v44, v44
s_waitcnt lgkmcnt(6)
s_waitcnt vmcnt(18)
v_mfma_f32_32x32x16_bf16 v[64:79], a[240:243], v[184:187], v[64:79]
ds_read_b64_tr_b16 a[236:237], v57 offset:4096
ds_read_b64_tr_b16 a[238:239], v57 offset:4608
buffer_load_dwordx4 v[232:235], v1, s[12:15], s42 offen offset:2048 sc1
buffer_load_dword v54, v10, s[12:15], s43 offen offset:1536 sc1
v_cvt_pk_bf16_f32 v60, v43, v43
v_and_b32 v44, 0xffff0000, v60
v_mfma_f32_32x32x16_bf16 v[80:95], a[244:247], v[184:187], v[80:95]
ds_read_b64_tr_b16 a[240:241], v56 offset:8192
ds_read_b64_tr_b16 a[242:243], v56 offset:8704
v_sub_f32 v44, v43, v44
v_cvt_pk_bf16_f32 v61, v44, v44
s_waitcnt vmcnt(19)
v_mfma_f32_32x32x16_bf16 v[64:79], a[248:251], v[188:191], v[64:79]
ds_read_b64_tr_b16 a[244:245], v57 offset:8192
ds_read_b64_tr_b16 a[246:247], v57 offset:8704
buffer_load_dwordx4 v[236:239], v1, s[12:15], s42 offen offset:3072 sc1
s_xor_b32 s42, s42, 0x1000
buffer_load_dword v55, v10, s[12:15], s43 offen offset:1792 sc1
v_mfma_f32_32x32x16_bf16 v[80:95], a[252:255], v[188:191], v[80:95]
ds_read_b64_tr_b16 a[248:249], v56 offset:12288
ds_read_b64_tr_b16 a[250:251], v56 offset:12800
s_waitcnt lgkmcnt(6)
s_waitcnt vmcnt(20)
v_mfma_f32_32x32x16_bf16 v[64:79], a[224:227], v[192:195], v[64:79]
ds_read_b64_tr_b16 a[252:253], v57 offset:12288
ds_read_b64_tr_b16 a[254:255], v57 offset:12800
buffer_load_dwordx4 v[240:243], v1, s[12:15], s42 offen offset:0 sc1
v_mfma_f32_32x32x16_bf16 v[80:95], a[228:231], v[192:195], v[80:95]
ds_read_b64_tr_b16 a[224:225], v56 offset:16384
ds_read_b64_tr_b16 a[226:227], v56 offset:16896
s_waitcnt vmcnt(20)
v_mfma_f32_32x32x16_bf16 v[64:79], a[232:235], v[196:199], v[64:79]
ds_read_b64_tr_b16 a[228:229], v57 offset:16384
ds_read_b64_tr_b16 a[230:231], v57 offset:16896
buffer_load_dwordx4 v[244:247], v1, s[12:15], s42 offen offset:1024 sc1
v_mfma_f32_32x32x16_bf16 v[80:95], a[236:239], v[196:199], v[80:95]
ds_read_b64_tr_b16 a[232:233], v56 offset:20480
ds_read_b64_tr_b16 a[234:235], v56 offset:20992
s_waitcnt lgkmcnt(6)
s_waitcnt vmcnt(20)
v_mfma_f32_32x32x16_bf16 v[64:79], a[240:243], v[200:203], v[64:79]
ds_read_b64_tr_b16 a[236:237], v57 offset:20480
ds_read_b64_tr_b16 a[238:239], v57 offset:20992
buffer_load_dwordx4 v[248:251], v1, s[12:15], s42 offen offset:2048 sc1
v_mfma_f32_32x32x16_bf16 v[80:95], a[244:247], v[200:203], v[80:95]
ds_read_b64_tr_b16 a[240:241], v56 offset:24576
ds_read_b64_tr_b16 a[242:243], v56 offset:25088
s_waitcnt vmcnt(20)
v_mfma_f32_32x32x16_bf16 v[64:79], a[248:251], v[204:207], v[64:79]
ds_read_b64_tr_b16 a[244:245], v57 offset:24576
ds_read_b64_tr_b16 a[246:247], v57 offset:25088
buffer_load_dwordx4 v[252:255], v1, s[12:15], s42 offen offset:3072 sc1
s_xor_b32 s42, s42, 0x7000
v_mfma_f32_32x32x16_bf16 v[80:95], a[252:255], v[204:207], v[80:95]
ds_read_b64_tr_b16 a[248:249], v56 offset:28672
ds_read_b64_tr_b16 a[250:251], v56 offset:29184
s_waitcnt lgkmcnt(6)
s_waitcnt vmcnt(20)
v_mfma_f32_32x32x16_bf16 v[64:79], a[224:227], v[208:211], v[64:79]
ds_read_b64_tr_b16 a[252:253], v57 offset:28672
ds_read_b64_tr_b16 a[254:255], v57 offset:29184
v_mfma_f32_32x32x16_bf16 v[80:95], a[228:231], v[208:211], v[80:95]
ds_read_b64_tr_b16 a[224:225], v56 offset:32768
ds_read_b64_tr_b16 a[226:227], v56 offset:33280
s_waitcnt vmcnt(17)
v_mfma_f32_32x32x16_bf16 v[64:79], a[232:235], v[212:215], v[64:79]
ds_read_b64_tr_b16 a[228:229], v57 offset:32768
ds_read_b64_tr_b16 a[230:231], v57 offset:33280
v_mfma_f32_32x32x16_bf16 v[80:95], a[236:239], v[212:215], v[80:95]
ds_read_b64_tr_b16 a[232:233], v56 offset:36864
ds_read_b64_tr_b16 a[234:235], v56 offset:37376
buffer_load_dwordx4 a[128:131], v1, s[12:15], s38 offen offset:0 sc1
s_waitcnt lgkmcnt(6)
s_waitcnt vmcnt(16)
v_mfma_f32_32x32x16_bf16 v[64:79], a[240:243], v[216:219], v[64:79]
ds_read_b64_tr_b16 a[236:237], v57 offset:36864
ds_read_b64_tr_b16 a[238:239], v57 offset:37376
v_mfma_f32_32x32x16_bf16 v[80:95], a[244:247], v[216:219], v[80:95]
ds_read_b64_tr_b16 a[240:241], v56 offset:40960
ds_read_b64_tr_b16 a[242:243], v56 offset:41472
buffer_load_dwordx4 a[132:135], v1, s[12:15], s38 offen offset:1024 sc1
s_waitcnt vmcnt(15)
v_mfma_f32_32x32x16_bf16 v[64:79], a[248:251], v[220:223], v[64:79]
ds_read_b64_tr_b16 a[244:245], v57 offset:40960
ds_read_b64_tr_b16 a[246:247], v57 offset:41472
v_mfma_f32_32x32x16_bf16 v[80:95], a[252:255], v[220:223], v[80:95]
ds_read_b64_tr_b16 a[248:249], v56 offset:45056
ds_read_b64_tr_b16 a[250:251], v56 offset:45568
buffer_load_dwordx4 a[136:139], v1, s[12:15], s38 offen offset:2048 sc1
s_waitcnt lgkmcnt(6)
s_waitcnt vmcnt(14)
v_mfma_f32_32x32x16_bf16 v[64:79], a[224:227], v[224:227], v[64:79]
ds_read_b64_tr_b16 a[252:253], v57 offset:45056
ds_read_b64_tr_b16 a[254:255], v57 offset:45568
v_mfma_f32_32x32x16_bf16 v[80:95], a[228:231], v[224:227], v[80:95]
ds_read_b64_tr_b16 a[224:225], v56 offset:49152
ds_read_b64_tr_b16 a[226:227], v56 offset:49664
buffer_load_dwordx4 a[140:143], v1, s[12:15], s38 offen offset:3072 sc1
s_add_u32 s38, s38, 4096
s_waitcnt vmcnt(13)
v_mfma_f32_32x32x16_bf16 v[64:79], a[232:235], v[228:231], v[64:79]
ds_read_b64_tr_b16 a[228:229], v57 offset:49152
ds_read_b64_tr_b16 a[230:231], v57 offset:49664
v_mfma_f32_32x32x16_bf16 v[80:95], a[236:239], v[228:231], v[80:95]
ds_read_b64_tr_b16 a[232:233], v56 offset:53248
ds_read_b64_tr_b16 a[234:235], v56 offset:53760
buffer_load_dwordx4 a[144:147], v1, s[12:15], s38 offen offset:0 sc1
s_waitcnt lgkmcnt(6)
s_waitcnt vmcnt(12)
v_mfma_f32_32x32x16_bf16 v[64:79], a[240:243], v[232:235], v[64:79]
ds_read_b64_tr_b16 a[236:237], v57 offset:53248
ds_read_b64_tr_b16 a[238:239], v57 offset:53760
v_add_f32 v48, v48, v52
v_add_f32 v49, v49, v53
s_waitcnt vmcnt(11)
v_add_f32 v50, v50, v54
v_mfma_f32_32x32x16_bf16 v[80:95], a[244:247], v[232:235], v[80:95]
ds_read_b64_tr_b16 a[240:241], v56 offset:57344
ds_read_b64_tr_b16 a[242:243], v56 offset:57856
buffer_load_dwordx2 v[38:39], v7, s[12:15], 0 offen offset:768 sc1
buffer_load_dwordx4 a[148:151], v1, s[12:15], s38 offen offset:1024 sc1
s_waitcnt vmcnt(11)
v_add_f32 v51, v51, v55
v_add_f32 v48, v48, v50
v_mfma_f32_32x32x16_bf16 v[64:79], a[248:251], v[236:239], v[64:79]
ds_read_b64_tr_b16 a[244:245], v57 offset:57344
ds_read_b64_tr_b16 a[246:247], v57 offset:57856
v_add_f32 v49, v49, v51
v_add_f32 v48, v48, v49
v_mfma_f32_32x32x16_bf16 v[80:95], a[252:255], v[236:239], v[80:95]
ds_read_b64_tr_b16 a[248:249], v56 offset:61440
ds_read_b64_tr_b16 a[250:251], v56 offset:61952
v_xor_b32 v56, 0x10000, v56
buffer_load_dwordx4 a[152:155], v1, s[12:15], s38 offen offset:2048 sc1
v_mov_b32 v49, v48
s_nop 1
v_permlane32_swap_b32 v48, v49
s_waitcnt lgkmcnt(6)
s_waitcnt vmcnt(11)
v_mfma_f32_32x32x16_bf16 v[64:79], a[224:227], v[240:243], v[64:79]
ds_read_b64_tr_b16 a[252:253], v57 offset:61440
ds_read_b64_tr_b16 a[254:255], v57 offset:61952
v_xor_b32 v57, 0x10000, v57
v_mul_f32 v48, 0xbb000000, v48
v_mul_f32 v49, 0x3b000000, v49
v_mfma_f32_32x32x16_bf16 v[80:95], a[228:231], v[240:243], v[80:95]
ds_read_b64_tr_b16 a[224:225], v2 offset:0
ds_read_b64_tr_b16 a[226:227], v2 offset:512
buffer_load_dwordx4 a[156:159], v1, s[12:15], s38 offen offset:3072 sc1
s_add_u32 s38, s38, 4096
v_cvt_pk_bf16_f32 v50, v48, v48
v_fma_f32 v49, -v48, v48, v49
v_and_b32 v50, 0xffff0000, v50
s_waitcnt vmcnt(11)
v_mfma_f32_32x32x16_bf16 v[64:79], a[232:235], v[244:247], v[64:79]
ds_read_b64_tr_b16 a[228:229], v5 offset:0
ds_read_b64_tr_b16 a[230:231], v5 offset:512
v_max_f32 v49, 0, v49
v_sub_f32 v48, v48, v50
v_mfma_f32_32x32x16_bf16 v[80:95], a[236:239], v[244:247], v[80:95]
ds_read_b64_tr_b16 a[232:233], v2 offset:4096
ds_read_b64_tr_b16 a[234:235], v2 offset:4608
buffer_load_dwordx4 a[160:163], v1, s[12:15], s38 offen offset:0 sc1
v_add_f32 v49, 0x3727c5ac, v49
v_cvt_pk_bf16_f32 v28, v50, v48
s_waitcnt lgkmcnt(6)
s_waitcnt vmcnt(11)
v_mfma_f32_32x32x16_bf16 v[64:79], a[240:243], v[248:251], v[64:79]
ds_read_b64_tr_b16 a[236:237], v5 offset:4096
ds_read_b64_tr_b16 a[238:239], v5 offset:4608
v_cvt_pk_bf16_f32 v29, v50, v48
v_rsq_f32 v33, v49
v_mfma_f32_32x32x16_bf16 v[80:95], a[244:247], v[248:251], v[80:95]
ds_read_b64_tr_b16 a[240:241], v2 offset:8192
ds_read_b64_tr_b16 a[242:243], v2 offset:8704
buffer_load_dwordx4 a[164:167], v1, s[12:15], s38 offen offset:1024 sc1
v_sqrt_f32 v32, v49
s_waitcnt vmcnt(11)
v_mfma_f32_32x32x16_bf16 v[64:79], a[248:251], v[252:255], v[64:79]
ds_read_b64_tr_b16 a[244:245], v5 offset:8192
ds_read_b64_tr_b16 a[246:247], v5 offset:8704
v_mul_f32 v33, 0xbfb8aa3b, v33
v_mfma_f32_32x32x16_bf16 v[80:95], a[252:255], v[252:255], v[80:95]
ds_read_b64_tr_b16 a[248:249], v2 offset:12288
ds_read_b64_tr_b16 a[250:251], v2 offset:12800
v_mfma_f32_32x32x8_bf16 v[64:79], v[16:17], v[28:29], v[64:79]
v_mfma_f32_32x32x8_bf16 v[80:95], v[18:19], v[28:29], v[80:95]
s_waitcnt lgkmcnt(6)
v_mfma_f32_32x32x16_bf16 v[96:111], a[224:227], v[128:131], 0
ds_read_b64_tr_b16 a[252:253], v5 offset:12288
ds_read_b64_tr_b16 a[254:255], v5 offset:12800
buffer_load_dwordx4 a[168:171], v1, s[12:15], s38 offen offset:2048 sc1
v_mfma_f32_32x32x16_bf16 v[112:127], a[228:231], v[128:131], 0
ds_read_b64_tr_b16 a[224:225], v2 offset:16384
ds_read_b64_tr_b16 a[226:227], v2 offset:16896
s_waitcnt vmcnt(6)
v_cmp_eq_u64 vcc, s[82:83], v[38:39]
s_nop 0
s_cmp_eq_u32 vcc_lo, 0xff
s_cbranch_scc0 L_spin_hb
L_ok_hb:
buffer_load_dwordx4 v[128:131], v8, s[12:15], s42 offen offset:0 sc1
v_mfma_f32_32x32x16_bf16 v[96:111], a[232:235], v[132:135], v[96:111]
ds_read_b64_tr_b16 a[228:229], v5 offset:16384
ds_read_b64_tr_b16 a[230:231], v5 offset:16896
v_mul_f32 v64, v33, v64
v_mul_f32 v65, v33, v65
v_mfma_f32_32x32x16_bf16 v[112:127], a[236:239], v[132:135], v[112:127]
ds_read_b64_tr_b16 a[232:233], v2 offset:20480
ds_read_b64_tr_b16 a[234:235], v2 offset:20992
buffer_load_dwordx4 v[132:135], v8, s[12:15], s42 offen offset:1024 sc1
s_waitcnt lgkmcnt(6)
v_mfma_f32_32x32x16_bf16 v[96:111], a[240:243], v[136:139], v[96:111]
ds_read_b64_tr_b16 a[236:237], v5 offset:20480
ds_read_b64_tr_b16 a[238:239], v5 offset:20992
v_exp_f32 v64, v64
v_mul_f32 v66, v33, v66
v_mfma_f32_32x32x16_bf16 v[112:127], a[244:247], v[136:139], v[112:127]
ds_read_b64_tr_b16 a[240:241], v2 offset:24576
ds_read_b64_tr_b16 a[242:243], v2 offset:25088
buffer_load_dwordx4 v[136:139], v8, s[12:15], s42 offen offset:2048 sc1
v_exp_f32 v65, v65
v_mfma_f32_32x32x16_bf16 v[96:111], a[248:251], v[140:143], v[96:111]
ds_read_b64_tr_b16 a[244:245], v5 offset:24576
ds_read_b64_tr_b16 a[246:247], v5 offset:25088
v_fma_f32 v64, v64, v32, v32
v_mul_f32 v67, v33, v67
v_exp_f32 v66, v66
v_mfma_f32_32x32x16_bf16 v[112:127], a[252:255], v[140:143], v[112:127]
ds_read_b64_tr_b16 a[248:249], v2 offset:28672
ds_read_b64_tr_b16 a[250:251], v2 offset:29184
buffer_load_dwordx4 v[140:143], v8, s[12:15], s42 offen offset:3072 sc1
s_xor_b32 s42, s42, 0x1000
s_waitcnt lgkmcnt(6)
v_mfma_f32_32x32x16_bf16 v[96:111], a[224:227], v[144:147], v[96:111]
ds_read_b64_tr_b16 a[252:253], v5 offset:28672
ds_read_b64_tr_b16 a[254:255], v5 offset:29184
v_fma_f32 v65, v65, v32, v32
v_rcp_f32 v64, v64
v_mul_f32 v68, v33, v68
v_mfma_f32_32x32x16_bf16 v[112:127], a[228:231], v[144:147], v[112:127]
ds_read_b64_tr_b16 a[224:225], v2 offset:32768
ds_read_b64_tr_b16 a[226:227], v2 offset:33280
v_exp_f32 v67, v67
v_fma_f32 v66, v66, v32, v32
v_mfma_f32_32x32x16_bf16 v[96:111], a[232:235], v[148:151], v[96:111]
ds_read_b64_tr_b16 a[228:229], v5 offset:32768
ds_read_b64_tr_b16 a[230:231], v5 offset:33280
buffer_load_dwordx4 v[144:147], v8, s[12:15], s42 offen offset:0 sc1
v_rcp_f32 v65, v65
v_mul_f32 v64, v64, v72
v_mfma_f32_32x32x16_bf16 v[112:127], a[236:239], v[148:151], v[112:127]
ds_read_b64_tr_b16 a[232:233], v2 offset:36864
ds_read_b64_tr_b16 a[234:235], v2 offset:37376
v_mul_f32 v69, v33, v69
s_waitcnt lgkmcnt(6)
v_mfma_f32_32x32x16_bf16 v[96:111], a[240:243], v[152:155], v[96:111]
ds_read_b64_tr_b16 a[236:237], v5 offset:36864
ds_read_b64_tr_b16 a[238:239], v5 offset:37376
buffer_load_dwordx4 v[148:151], v8, s[12:15], s42 offen offset:1024 sc1
v_exp_f32 v68, v68
v_fma_f32 v67, v67, v32, v32
v_mfma_f32_32x32x16_bf16 v[112:127], a[244:247], v[152:155], v[112:127]
ds_read_b64_tr_b16 a[240:241], v2 offset:40960
ds_read_b64_tr_b16 a[242:243], v2 offset:41472
v_rcp_f32 v66, v66
v_mul_f32 v65, v65, v73
v_mfma_f32_32x32x16_bf16 v[96:111], a[248:251], v[156:159], v[96:111]
ds_read_b64_tr_b16 a[244:245], v5 offset:40960
ds_read_b64_tr_b16 a[246:247], v5 offset:41472
buffer_load_dwordx4 v[152:155], v8, s[12:15], s42 offen offset:2048 sc1
v_mul_f32 v70, v33, v70
v_exp_f32 v69, v69
v_mfma_f32_32x32x16_bf16 v[112:127], a[252:255], v[156:159], v[112:127]
ds_read_b64_tr_b16 a[248:249], v2 offset:45056
ds_read_b64_tr_b16 a[250:251], v2 offset:45568
v_fma_f32 v68, v68, v32, v32
s_waitcnt lgkmcnt(6)
v_mfma_f32_32x32x16_bf16 v[96:111], a[224:227], v[160:163], v[96:111]
ds_read_b64_tr_b16 a[252:253], v5 offset:45056
ds_read_b64_tr_b16 a[254:255], v5 offset:45568
buffer_load_dwordx4 a[172:175], v1, s[12:15], s38 offen offset:3072 sc1
s_add_u32 s38, s38, 4096
v_rcp_f32 v67, v67
v_mfma_f32_32x32x16_bf16 v[112:127], a[228:231], v[160:163], v[112:127]
ds_read_b64_tr_b16 a[224:225], v2 offset:49152
ds_read_b64_tr_b16 a[226:227], v2 offset:49664
buffer_load_dwordx4 v[156:159], v8, s[12:15], s42 offen offset:3072 sc1
s_xor_b32 s42, s42, 0x3000
v_mul_f32 v66, v66, v74
v_mfma_f32_32x32x16_bf16 v[96:111], a[232:235], v[164:167], v[96:111]
ds_read_b64_tr_b16 a[228:229], v5 offset:49152
ds_read_b64_tr_b16 a[230:231], v5 offset:49664
v_cvt_pk_bf16_f32 v40, v64, v65
v_mul_f32 v71, v33, v71
v_exp_f32 v70, v70
v_mfma_f32_32x32x16_bf16 v[112:127], a[236:239], v[164:167], v[112:127]
ds_read_b64_tr_b16 a[232:233], v2 offset:53248
ds_read_b64_tr_b16 a[234:235], v2 offset:53760
buffer_load_dwordx4 v[160:163], v8, s[12:15], s42 offen offset:0 sc1
v_fma_f32 v69, v69, v32, v32
s_waitcnt lgkmcnt(6)
v_mfma_f32_32x32x16_bf16 v[96:111], a[240:243], v[168:171], v[96:111]
ds_read_b64_tr_b16 a[236:237], v5 offset:53248
ds_read_b64_tr_b16 a[238:239], v5 offset:53760
v_rcp_f32 v68, v68
v_mul_f32 v67, v67, v75
v_mfma_f32_32x32x16_bf16 v[112:127], a[244:247], v[168:171], v[112:127]
ds_read_b64_tr_b16 a[240:241], v2 offset:57344
ds_read_b64_tr_b16 a[242:243], v2 offset:57856
buffer_load_dwordx4 v[164:167], v8, s[12:15], s42 offen offset:1024 sc1
v_exp_f32 v71, v71
v_mfma_f32_32x32x16_bf16 v[96:111], a[248:251], v[172:175], v[96:111]
ds_read_b64_tr_b16 a[244:245], v5 offset:57344
ds_read_b64_tr_b16 a[246:247], v5 offset:57856
v_fma_f32 v70, v70, v32, v32
v_rcp_f32 v69, v69
v_mul_f32 v68, v68, v76
v_mfma_f32_32x32x16_bf16 v[112:127], a[252:255], v[172:175], v[112:127]
ds_read_b64_tr_b16 a[248:249], v2 offset:61440
ds_read_b64_tr_b16 a[250:251], v2 offset:61952
v_xor_b32 v2, 0x10000, v2
v_cvt_pk_bf16_f32 v41, v66, v67
s_waitcnt lgkmcnt(6)
v_mfma_f32_32x32x16_bf16 v[96:111], a[224:227], v[176:179], v[96:111]
ds_read_b64_tr_b16 a[252:253], v5 offset:61440
ds_read_b64_tr_b16 a[254:255], v5 offset:61952
v_xor_b32 v5, 0x10000, v5
buffer_load_dwordx4 v[168:171], v8, s[12:15], s42 offen offset:2048 sc1
v_fma_f32 v71, v71, v32, v32
v_mfma_f32_32x32x16_bf16 v[112:127], a[228:231], v[176:179], v[112:127]
ds_read_b64_tr_b16 a[224:225], v2 offset:0
ds_read_b64_tr_b16 a[226:227], v2 offset:512
v_rcp_f32 v70, v70
v_mul_f32 v69, v69, v77
v_mfma_f32_32x32x16_bf16 v[96:111], a[232:235], v[180:183], v[96:111]
ds_read_b64_tr_b16 a[228:229], v5 offset:0
ds_read_b64_tr_b16 a[230:231], v5 offset:512
buffer_load_dwordx4 v[172:175], v8, s[12:15], s42 offen offset:3072 sc1
s_xor_b32 s42, s42, 0x1000
v_rcp_f32 v71, v71
v_mfma_f32_32x32x16_bf16 v[112:127], a[236:239], v[180:183], v[112:127]
ds_read_b64_tr_b16 a[232:233], v2 offset:4096
ds_read_b64_tr_b16 a[234:235], v2 offset:4608
v_mul_f32 v70, v70, v78
v_cvt_pk_bf16_f32 v42, v68, v69
s_waitcnt lgkmcnt(6)
v_mfma_f32_32x32x16_bf16 v[96:111], a[240:243], v[184:187], v[96:111]
ds_read_b64_tr_b16 a[236:237], v5 offset:4096
ds_read_b64_tr_b16 a[238:239], v5 offset:4608
buffer_load_dwordx4 v[176:179], v8, s[12:15], s42 offen offset:0 sc1
buffer_load_dword v48, v10, s[12:15], s43 offen offset:2048 sc1
v_mul_f32 v71, v71, v79
v_cvt_pk_bf16_f32 v43, v70, v71
v_mfma_f32_32x32x16_bf16 v[112:127], a[244:247], v[184:187], v[112:127]
ds_read_b64_tr_b16 a[240:241], v2 offset:8192
ds_read_b64_tr_b16 a[242:243], v2 offset:8704
buffer_store_dwordx4 v[40:43], v1, s[12:15], s39 offen sc1
s_add_u32 s39, s39, 7168
v_mfma_f32_32x32x16_bf16 v[96:111], a[248:251], v[188:191], v[96:111]
ds_read_b64_tr_b16 a[244:245], v5 offset:8192
ds_read_b64_tr_b16 a[246:247], v5 offset:8704
buffer_load_dwordx4 v[180:183], v8, s[12:15], s42 offen offset:1024 sc1
buffer_load_dword v49, v10, s[12:15], s43 offen offset:2304 sc1
v_mfma_f32_32x32x16_bf16 v[112:127], a[252:255], v[188:191], v[112:127]
ds_read_b64_tr_b16 a[248:249], v2 offset:12288
ds_read_b64_tr_b16 a[250:251], v2 offset:12800
v_mul_f32 v80, v33, v80
v_mul_f32 v81, v33, v81
s_waitcnt lgkmcnt(6)
v_mfma_f32_32x32x16_bf16 v[96:111], a[224:227], v[192:195], v[96:111]
ds_read_b64_tr_b16 a[252:253], v5 offset:12288
ds_read_b64_tr_b16 a[254:255], v5 offset:12800
buffer_load_dwordx4 a[176:179], v1, s[12:15], s38 offen offset:0 sc1
v_exp_f32 v80, v80
v_mul_f32 v82, v33, v82
v_mfma_f32_32x32x16_bf16 v[112:127], a[228:231], v[192:195], v[112:127]
ds_read_b64_tr_b16 a[224:225], v2 offset:16384
ds_read_b64_tr_b16 a[226:227], v2 offset:16896
buffer_load_dwordx4 v[184:187], v8, s[12:15], s42 offen offset:2048 sc1
buffer_load_dword v50, v10, s[12:15], s43 offen offset:2560 sc1
v_mfma_f32_32x32x16_bf16 v[96:111], a[232:235], v[196:199], v[96:111]
ds_read_b64_tr_b16 a[228:229], v5 offset:16384
ds_read_b64_tr_b16 a[230:231], v5 offset:16896
v_exp_f32 v81, v81
v_fma_f32 v80, v80, v32, v32
v_mul_f32 v83, v33, v83
v_mfma_f32_32x32x16_bf16 v[112:127], a[236:239], v[196:199], v[112:127]
ds_read_b64_tr_b16 a[232:233], v2 offset:20480
ds_read_b64_tr_b16 a[234:235], v2 offset:20992
buffer_load_dwordx4 v[188:191], v8, s[12:15], s42 offen offset:3072 sc1
s_xor_b32 s42, s42, 0x7000
buffer_load_dword v51, v10, s[12:15], s43 offen offset:2816 sc1
s_waitcnt lgkmcnt(6)
v_mfma_f32_32x32x16_bf16 v[96:111], a[240:243], v[200:203], v[96:111]
ds_read_b64_tr_b16 a[236:237], v5 offset:20480
ds_read_b64_tr_b16 a[238:239], v5 offset:20992
v_exp_f32 v82, v82
v_fma_f32 v81, v81, v32, v32
v_mfma_f32_32x32x16_bf16 v[112:127], a[244:247], v[200:203], v[112:127]
ds_read_b64_tr_b16 a[240:241], v2 offset:24576
ds_read_b64_tr_b16 a[242:243], v2 offset:25088
buffer_load_dwordx4 v[192:195], v8, s[12:15], s42 offen offset:0 sc1
buffer_load_dword v52, v10, s[12:15], s43 offen offset:3072 sc1
v_mfma_f32_32x32x16_bf16 v[96:111], a[248:251], v[204:207], v[96:111]
ds_read_b64_tr_b16 a[244:245], v5 offset:24576
ds_read_b64_tr_b16 a[246:247], v5 offset:25088
v_rcp_f32 v80, v80
v_mul_f32 v84, v33, v84
v_mfma_f32_32x32x16_bf16 v[112:127], a[252:255], v[204:207], v[112:127]
ds_read_b64_tr_b16 a[248:249], v2 offset:28672
ds_read_b64_tr_b16 a[250:251], v2 offset:29184
v_exp_f32 v83, v83
s_waitcnt lgkmcnt(6)
v_mfma_f32_32x32x16_bf16 v[96:111], a[224:227], v[208:211], v[96:111]
ds_read_b64_tr_b16 a[252:253], v5 offset:28672
ds_read_b64_tr_b16 a[254:255], v5 offset:29184
buffer_load_dwordx4 v[196:199], v8, s[12:15], s42 offen offset:1024 sc1
buffer_load_dword v53, v10, s[12:15], s43 offen offset:3328 sc1
v_fma_f32 v82, v82, v32, v32
v_mfma_f32_32x32x16_bf16 v[112:127], a[228:231], v[208:211], v[112:127]
ds_read_b64_tr_b16 a[224:225], v2 offset:32768
ds_read_b64_tr_b16 a[226:227], v2 offset:33280
v_rcp_f32 v81, v81
v_mul_f32 v80, v80, v88
v_mfma_f32_32x32x16_bf16 v[96:111], a[232:235], v[212:215], v[96:111]
ds_read_b64_tr_b16 a[228:229], v5 offset:32768
ds_read_b64_tr_b16 a[230:231], v5 offset:33280
buffer_load_dwordx4 v[200:203], v8, s[12:15], s42 offen offset:2048 sc1
buffer_load_dword v54, v10, s[12:15], s43 offen offset:3584 sc1
v_mul_f32 v85, v33, v85
v_mfma_f32_32x32x16_bf16 v[112:127], a[236:239], v[212:215], v[112:127]
ds_read_b64_tr_b16 a[232:233], v2 offset:36864
ds_read_b64_tr_b16 a[234:235], v2 offset:37376
v_exp_f32 v84, v84
s_waitcnt lgkmcnt(6)
v_mfma_f32_32x32x16_bf16 v[96:111], a[240:243], v[216:219], v[96:111]
ds_read_b64_tr_b16 a[236:237], v5 offset:36864
ds_read_b64_tr_b16 a[238:239], v5 offset:37376
buffer_load_dwordx4 v[204:207], v8, s[12:15], s42 offen offset:3072 sc1
s_xor_b32 s42, s42, 0x1000
buffer_load_dword v55, v10, s[12:15], s43 offen offset:3840 sc1
v_fma_f32 v83, v83, v32, v32
v_mfma_f32_32x32x16_bf16 v[112:127], a[244:247], v[216:219], v[112:127]
ds_read_b64_tr_b16 a[240:241], v2 offset:40960
ds_read_b64_tr_b16 a[242:243], v2 offset:41472
v_rcp_f32 v82, v82
v_mul_f32 v81, v81, v89
v_mul_f32 v86, v33, v86
v_mfma_f32_32x32x16_bf16 v[96:111], a[248:251], v[220:223], v[96:111]
ds_read_b64_tr_b16 a[244:245], v5 offset:40960
ds_read_b64_tr_b16 a[246:247], v5 offset:41472
v_exp_f32 v85, v85
v_fma_f32 v84, v84, v32, v32
v_mfma_f32_32x32x16_bf16 v[112:127], a[252:255], v[220:223], v[112:127]
ds_read_b64_tr_b16 a[248:249], v2 offset:45056
ds_read_b64_tr_b16 a[250:251], v2 offset:45568
buffer_load_dwordx4 v[208:211], v8, s[12:15], s42 offen offset:0 sc1
v_rcp_f32 v83, v83
s_waitcnt lgkmcnt(6)
v_mfma_f32_32x32x16_bf16 v[96:111], a[224:227], v[224:227], v[96:111]
ds_read_b64_tr_b16 a[252:253], v5 offset:45056
ds_read_b64_tr_b16 a[254:255], v5 offset:45568
buffer_load_dwordx4 a[180:183], v1, s[12:15], s38 offen offset:1024 sc1
v_mul_f32 v82, v82, v90
v_cvt_pk_bf16_f32 v40, v80, v81
v_mfma_f32_32x32x16_bf16 v[112:127], a[228:231], v[224:227], v[112:127]
ds_read_b64_tr_b16 a[224:225], v2 offset:49152
ds_read_b64_tr_b16 a[226:227], v2 offset:49664
buffer_load_dwordx4 v[212:215], v8, s[12:15], s42 offen offset:1024 sc1
v_mul_f32 v87, v33, v87
v_exp_f32 v86, v86
v_mfma_f32_32x32x16_bf16 v[96:111], a[232:235], v[228:231], v[96:111]
ds_read_b64_tr_b16 a[228:229], v5 offset:49152
ds_read_b64_tr_b16 a[230:231], v5 offset:49664
v_fma_f32 v85, v85, v32, v32
v_rcp_f32 v84, v84
v_mfma_f32_32x32x16_bf16 v[112:127], a[236:239], v[228:231], v[112:127]
ds_read_b64_tr_b16 a[232:233], v2 offset:53248
ds_read_b64_tr_b16 a[234:235], v2 offset:53760
buffer_load_dwordx4 v[216:219], v8, s[12:15], s42 offen offset:2048 sc1
v_mul_f32 v83, v83, v91
s_waitcnt lgkmcnt(6)
v_mfma_f32_32x32x16_bf16 v[96:111], a[240:243], v[232:235], v[96:111]
ds_read_b64_tr_b16 a[236:237], v5 offset:53248
ds_read_b64_tr_b16 a[238:239], v5 offset:53760
v_exp_f32 v87, v87
v_fma_f32 v86, v86, v32, v32
v_mfma_f32_32x32x16_bf16 v[112:127], a[244:247], v[232:235], v[112:127]
ds_read_b64_tr_b16 a[240:241], v2 offset:57344
ds_read_b64_tr_b16 a[242:243], v2 offset:57856
buffer_load_dwordx4 v[220:223], v8, s[12:15], s42 offen offset:3072 sc1
s_xor_b32 s42, s42, 0x3000
v_rcp_f32 v85, v85
v_mfma_f32_32x32x16_bf16 v[96:111], a[248:251], v[236:239], v[96:111]
ds_read_b64_tr_b16 a[244:245], v5 offset:57344
ds_read_b64_tr_b16 a[246:247], v5 offset:57856
v_mul_f32 v84, v84, v92
v_cvt_pk_bf16_f32 v41, v82, v83
v_fma_f32 v87, v87, v32, v32
v_mfma_f32_32x32x16_bf16 v[112:127], a[252:255], v[236:239], v[112:127]
ds_read_b64_tr_b16 a[248:249], v2 offset:61440
ds_read_b64_tr_b16 a[250:251], v2 offset:61952
v_xor_b32 v2, 0x10000, v2
v_rcp_f32 v86, v86
s_waitcnt lgkmcnt(6)
v_mfma_f32_32x32x16_bf16 v[96:111], a[224:227], v[240:243], v[96:111]
ds_read_b64_tr_b16 a[252:253], v5 offset:61440
ds_read_b64_tr_b16 a[254:255], v5 offset:61952
v_xor_b32 v5, 0x10000, v5
buffer_load_dwordx4 v[224:227], v8, s[12:15], s42 offen offset:0 sc1
v_mul_f32 v85, v85, v93
v_mfma_f32_32x32x16_bf16 v[112:127], a[228:231], v[240:243], v[112:127]
ds_read_b64_tr_b16 a[224:225], v56 offset:0
ds_read_b64_tr_b16 a[226:227], v56 offset:512
v_rcp_f32 v87, v87
v_mul_f32 v86, v86, v94
v_cvt_pk_bf16_f32 v42, v84, v85
v_mfma_f32_32x32x16_bf16 v[96:111], a[232:235], v[244:247], v[96:111]
ds_read_b64_tr_b16 a[228:229], v56 offset:4096
ds_read_b64_tr_b16 a[230:231], v56 offset:4608
buffer_load_dwordx4 v[228:231], v8, s[12:15], s42 offen offset:1024 sc1
v_mul_f32 v87, v87, v95
v_cvt_pk_bf16_f32 v43, v86, v87
v_mfma_f32_32x32x16_bf16 v[112:127], a[236:239], v[244:247], v[112:127]
ds_read_b64_tr_b16 a[232:233], v56 offset:8192
ds_read_b64_tr_b16 a[234:235], v56 offset:8704
buffer_store_dwordx4 v[40:43], v1, s[12:15], s39 offen sc1
s_add_u32 s39, s39, 7168
s_waitcnt lgkmcnt(6)
v_mfma_f32_32x32x16_bf16 v[96:111], a[240:243], v[248:251], v[96:111]
ds_read_b64_tr_b16 a[236:237], v56 offset:12288
ds_read_b64_tr_b16 a[238:239], v56 offset:12800
buffer_load_dwordx4 v[232:235], v8, s[12:15], s42 offen offset:2048 sc1
v_mfma_f32_32x32x16_bf16 v[112:127], a[244:247], v[248:251], v[112:127]
ds_read_b64_tr_b16 a[240:241], v56 offset:16384
ds_read_b64_tr_b16 a[242:243], v56 offset:16896
v_mfma_f32_32x32x16_bf16 v[96:111], a[248:251], v[252:255], v[96:111]
ds_read_b64_tr_b16 a[244:245], v56 offset:20480
ds_read_b64_tr_b16 a[246:247], v56 offset:20992
v_mfma_f32_32x32x16_bf16 v[112:127], a[252:255], v[252:255], v[112:127]
ds_read_b64_tr_b16 a[248:249], v56 offset:24576
ds_read_b64_tr_b16 a[250:251], v56 offset:25088
buffer_load_dwordx4 v[236:239], v8, s[12:15], s42 offen offset:3072 sc1
s_xor_b32 s42, s42, 0x1000
v_mfma_f32_32x32x8_bf16 v[96:111], v[58:59], v[28:29], v[96:111]
v_mfma_f32_32x32x8_bf16 v[112:127], v[60:61], v[28:29], v[112:127]
s_waitcnt lgkmcnt(6)
s_waitcnt vmcnt(40)
v_mfma_f32_32x32x16_bf16 v[64:79], a[224:227], v[128:131], 0
ds_read_b64_tr_b16 a[252:253], v56 offset:28672
ds_read_b64_tr_b16 a[254:255], v56 offset:29184
s_waitcnt vmcnt(39)
v_mfma_f32_32x32x16_bf16 v[64:79], a[228:231], v[132:135], v[64:79]
ds_read_b64_tr_b16 a[224:225], v56 offset:32768
ds_read_b64_tr_b16 a[226:227], v56 offset:33280
buffer_load_dwordx4 v[240:243], v8, s[12:15], s42 offen offset:0 sc1
s_waitcnt vmcnt(39)
v_mfma_f32_32x32x16_bf16 v[64:79], a[232:235], v[136:139], v[64:79]
ds_read_b64_tr_b16 a[228:229], v56 offset:36864
ds_read_b64_tr_b16 a[230:231], v56 offset:37376
v_mul_f32 v96, v33, v96
v_mul_f32 v97, v33, v97
v_exp_f32 v96, v96
v_mul_f32 v98, v33, v98
s_waitcnt vmcnt(38)
v_mfma_f32_32x32x16_bf16 v[64:79], a[236:239], v[140:143], v[64:79]
ds_read_b64_tr_b16 a[232:233], v56 offset:40960
ds_read_b64_tr_b16 a[234:235], v56 offset:41472
buffer_load_dwordx4 v[244:247], v8, s[12:15], s42 offen offset:1024 sc1
v_exp_f32 v97, v97
v_fma_f32 v96, v96, v32, v32
s_waitcnt lgkmcnt(6)
s_waitcnt vmcnt(38)
v_mfma_f32_32x32x16_bf16 v[64:79], a[240:243], v[144:147], v[64:79]
ds_read_b64_tr_b16 a[236:237], v56 offset:45056
ds_read_b64_tr_b16 a[238:239], v56 offset:45568
v_mul_f32 v99, v33, v99
v_exp_f32 v98, v98
v_fma_f32 v97, v97, v32, v32
s_waitcnt vmcnt(37)
v_mfma_f32_32x32x16_bf16 v[64:79], a[244:247], v[148:151], v[64:79]
ds_read_b64_tr_b16 a[240:241], v56 offset:49152
ds_read_b64_tr_b16 a[242:243], v56 offset:49664
v_rcp_f32 v96, v96
v_mul_f32 v100, v33, v100
v_exp_f32 v99, v99
s_waitcnt vmcnt(36)
v_mfma_f32_32x32x16_bf16 v[64:79], a[248:251], v[152:155], v[64:79]
ds_read_b64_tr_b16 a[244:245], v56 offset:53248
ds_read_b64_tr_b16 a[246:247], v56 offset:53760
buffer_load_dwordx4 v[248:251], v8, s[12:15], s42 offen offset:2048 sc1
s_waitcnt vmcnt(19)
v_add_f32 v48, v48, v52
v_fma_f32 v98, v98, v32, v32
v_rcp_f32 v97, v97
v_mfma_f32_32x32x16_bf16 v[64:79], a[252:255], v[156:159], v[64:79]
ds_read_b64_tr_b16 a[248:249], v56 offset:57344
ds_read_b64_tr_b16 a[250:251], v56 offset:57856
s_waitcnt vmcnt(17)
v_add_f32 v49, v49, v53
v_mul_f32 v96, v96, v104
v_mul_f32 v101, v33, v101
s_waitcnt lgkmcnt(6)
v_mfma_f32_32x32x16_bf16 v[64:79], a[224:227], v[160:163], v[64:79]
ds_read_b64_tr_b16 a[252:253], v56 offset:61440
ds_read_b64_tr_b16 a[254:255], v56 offset:61952
v_xor_b32 v56, 0x10000, v56
buffer_load_dwordx4 v[252:255], v8, s[12:15], s42 offen offset:3072 sc1
s_xor_b32 s42, s42, 0x7000
s_waitcnt vmcnt(16)
v_add_f32 v50, v50, v54
v_exp_f32 v100, v100
v_mfma_f32_32x32x16_bf16 v[64:79], a[228:231], v[164:167], v[64:79]
ds_read_b64_tr_b16 a[224:225], v56 offset:0
ds_read_b64_tr_b16 a[226:227], v56 offset:512
buffer_load_dwordx4 a[184:187], v1, s[12:15], s38 offen offset:2048 sc1
s_waitcnt vmcnt(15)
v_add_f32 v51, v51, v55
v_fma_f32 v99, v99, v32, v32
v_rcp_f32 v98, v98
v_mfma_f32_32x32x16_bf16 v[64:79], a[232:235], v[168:171], v[64:79]
ds_read_b64_tr_b16 a[228:229], v56 offset:4096
ds_read_b64_tr_b16 a[230:231], v56 offset:4608
v_add_f32 v48, v48, v50
v_mul_f32 v97, v97, v105
v_mul_f32 v102, v33, v102
v_exp_f32 v101, v101
v_mfma_f32_32x32x16_bf16 v[64:79], a[236:239], v[172:175], v[64:79]
ds_read_b64_tr_b16 a[232:233], v56 offset:8192
ds_read_b64_tr_b16 a[234:235], v56 offset:8704
buffer_load_dwordx4 a[188:191], v1, s[12:15], s38 offen offset:3072 sc1
s_add_u32 s38, s38, 4096
v_add_f32 v49, v49, v51
v_fma_f32 v100, v100, v32, v32
s_waitcnt lgkmcnt(6)
v_mfma_f32_32x32x16_bf16 v[64:79], a[240:243], v[176:179], v[64:79]
ds_read_b64_tr_b16 a[236:237], v56 offset:12288
ds_read_b64_tr_b16 a[238:239], v56 offset:12800
v_add_f32 v48, v48, v49
v_rcp_f32 v99, v99
v_mul_f32 v98, v98, v106
v_cvt_pk_bf16_f32 v40, v96, v97
v_mfma_f32_32x32x16_bf16 v[64:79], a[244:247], v[180:183], v[64:79]
ds_read_b64_tr_b16 a[240:241], v56 offset:16384
ds_read_b64_tr_b16 a[242:243], v56 offset:16896
buffer_load_dwordx4 a[192:195], v1, s[12:15], s38 offen offset:0 sc1
v_mov_b32 v49, v48
v_mul_f32 v103, v33, v103
v_exp_f32 v102, v102
s_waitcnt vmcnt(9)
buffer_store_dwordx2 v[34:35], v62, s[12:15], 0 offen offset:0 sc1
v_mfma_f32_32x32x16_bf16 v[64:79], a[248:251], v[184:187], v[64:79]
ds_read_b64_tr_b16 a[244:245], v56 offset:20480
ds_read_b64_tr_b16 a[246:247], v56 offset:20992
v_permlane32_swap_b32 v48, v49
v_fma_f32 v101, v101, v32, v32
v_rcp_f32 v100, v100
v_mul_f32 v99, v99, v107
v_mfma_f32_32x32x16_bf16 v[64:79], a[252:255], v[188:191], v[64:79]
ds_read_b64_tr_b16 a[248:249], v56 offset:24576
ds_read_b64_tr_b16 a[250:251], v56 offset:25088
buffer_load_dwordx4 a[196:199], v1, s[12:15], s38 offen offset:1024 sc1
v_mul_f32 v48, 0xbb000000, v48
v_exp_f32 v103, v103
s_waitcnt lgkmcnt(6)
v_mfma_f32_32x32x16_bf16 v[64:79], a[224:227], v[192:195], v[64:79]
ds_read_b64_tr_b16 a[252:253], v56 offset:28672
ds_read_b64_tr_b16 a[254:255], v56 offset:29184
v_mul_f32 v49, 0x3b000000, v49
v_fma_f32 v102, v102, v32, v32
v_rcp_f32 v101, v101
v_mul_f32 v100, v100, v108
v_mfma_f32_32x32x16_bf16 v[64:79], a[228:231], v[196:199], v[64:79]
ds_read_b64_tr_b16 a[224:225], v56 offset:32768
ds_read_b64_tr_b16 a[226:227], v56 offset:33280
v_cvt_pk_bf16_f32 v50, v48, v48
v_cvt_pk_bf16_f32 v41, v98, v99
v_fma_f32 v103, v103, v32, v32
v_rcp_f32 v102, v102
v_mfma_f32_32x32x16_bf16 v[64:79], a[232:235], v[200:203], v[64:79]
ds_read_b64_tr_b16 a[228:229], v56 offset:36864
ds_read_b64_tr_b16 a[230:231], v56 offset:37376
buffer_load_dwordx4 a[200:203], v1, s[12:15], s38 offen offset:2048 sc1
v_fma_f32 v49, -v48, v48, v49
v_mul_f32 v101, v101, v109
v_rcp_f32 v103, v103
v_mfma_f32_32x32x16_bf16 v[64:79], a[236:239], v[204:207], v[64:79]
ds_read_b64_tr_b16 a[232:233], v56 offset:40960
ds_read_b64_tr_b16 a[234:235], v56 offset:41472
v_and_b32 v50, 0xffff0000, v50
v_mul_f32 v102, v102, v110
v_cvt_pk_bf16_f32 v42, v100, v101
v_mul_f32 v103, v103, v111
s_waitcnt lgkmcnt(6)
v_mfma_f32_32x32x16_bf16 v[64:79], a[240:243], v[208:211], v[64:79]
ds_read_b64_tr_b16 a[236:237], v56 offset:45056
ds_read_b64_tr_b16 a[238:239], v56 offset:45568
buffer_load_dwordx4 a[204:207], v1, s[12:15], s38 offen offset:3072 sc1
s_add_u32 s38, s38, 4096
v_max_f32 v49, 0, v49
v_cvt_pk_bf16_f32 v43, v102, v103
buffer_store_dwordx4 v[40:43], v1, s[12:15], s39 offen sc1
s_add_u32 s39, s39, 7168
v_mfma_f32_32x32x16_bf16 v[64:79], a[244:247], v[212:215], v[64:79]
ds_read_b64_tr_b16 a[240:241], v56 offset:49152
ds_read_b64_tr_b16 a[242:243], v56 offset:49664
v_sub_f32 v48, v48, v50
v_mul_f32 v112, v33, v112
v_mul_f32 v113, v33, v113
v_mfma_f32_32x32x16_bf16 v[64:79], a[248:251], v[216:219], v[64:79]
ds_read_b64_tr_b16 a[244:245], v56 offset:53248
ds_read_b64_tr_b16 a[246:247], v56 offset:53760
buffer_load_dwordx4 a[208:211], v1, s[12:15], s38 offen offset:0 sc1
v_add_f32 v49, 0x3727c5ac, v49
v_exp_f32 v112, v112
v_mfma_f32_32x32x16_bf16 v[64:79], a[252:255], v[220:223], v[64:79]
ds_read_b64_tr_b16 a[248:249], v56 offset:57344
ds_read_b64_tr_b16 a[250:251], v56 offset:57856
v_cvt_pk_bf16_f32 v28, v50, v48
v_mul_f32 v114, v33, v114
v_exp_f32 v113, v113
s_waitcnt lgkmcnt(6)
v_mfma_f32_32x32x16_bf16 v[64:79], a[224:227], v[224:227], v[64:79]
ds_read_b64_tr_b16 a[252:253], v56 offset:61440
ds_read_b64_tr_b16 a[254:255], v56 offset:61952
v_cvt_pk_bf16_f32 v29, v50, v48
v_fma_f32 v112, v112, v32, v32
v_mul_f32 v115, v33, v115
v_mfma_f32_32x32x16_bf16 v[64:79], a[228:231], v[228:231], v[64:79]
ds_read_b64_tr_b16 a[224:225], v57 offset:0
ds_read_b64_tr_b16 a[226:227], v57 offset:512
buffer_load_dwordx4 a[212:215], v1, s[12:15], s38 offen offset:1024 sc1
v_rsq_f32 v31, v49
s_waitcnt vmcnt(15)
v_mfma_f32_32x32x16_bf16 v[64:79], a[232:235], v[232:235], v[64:79]
ds_read_b64_tr_b16 a[228:229], v57 offset:4096
ds_read_b64_tr_b16 a[230:231], v57 offset:4608
v_exp_f32 v114, v114
v_fma_f32 v113, v113, v32, v32
v_rcp_f32 v112, v112
s_waitcnt vmcnt(14)
v_mfma_f32_32x32x16_bf16 v[64:79], a[236:239], v[236:239], v[64:79]
ds_read_b64_tr_b16 a[232:233], v57 offset:8192
ds_read_b64_tr_b16 a[234:235], v57 offset:8704
buffer_load_dwordx4 a[216:219], v1, s[12:15], s38 offen offset:2048 sc1
v_sqrt_f32 v30, v49
s_waitcnt lgkmcnt(6)
s_waitcnt vmcnt(14)
v_mfma_f32_32x32x16_bf16 v[64:79], a[240:243], v[240:243], v[64:79]
ds_read_b64_tr_b16 a[236:237], v57 offset:12288
ds_read_b64_tr_b16 a[238:239], v57 offset:12800
v_mul_f32 v116, v33, v116
v_exp_f32 v115, v115
v_fma_f32 v114, v114, v32, v32
s_waitcnt vmcnt(13)
v_mfma_f32_32x32x16_bf16 v[64:79], a[244:247], v[244:247], v[64:79]
ds_read_b64_tr_b16 a[240:241], v57 offset:16384
ds_read_b64_tr_b16 a[242:243], v57 offset:16896
buffer_load_dwordx4 a[220:223], v1, s[12:15], s38 offen offset:3072 sc1
s_sub_u32 s38, s38, 53248
v_mul_f32 v31, 0xbfb8aa3b, v31
v_rcp_f32 v113, v113
s_waitcnt vmcnt(13)
v_mfma_f32_32x32x16_bf16 v[64:79], a[248:251], v[248:251], v[64:79]
ds_read_b64_tr_b16 a[244:245], v57 offset:20480
ds_read_b64_tr_b16 a[246:247], v57 offset:20992
v_mul_f32 v112, v112, v120
v_mul_f32 v117, v33, v117
v_exp_f32 v116, v116
s_waitcnt vmcnt(12)
v_mfma_f32_32x32x16_bf16 v[64:79], a[252:255], v[252:255], v[64:79]
ds_read_b64_tr_b16 a[248:249], v57 offset:24576
ds_read_b64_tr_b16 a[250:251], v57 offset:25088
v_fma_f32 v115, v115, v32, v32
v_rcp_f32 v114, v114
v_mul_f32 v113, v113, v121
v_mfma_f32_32x32x8_bf16 v[64:79], v[16:17], v[28:29], v[64:79]
v_mul_f32 v118, v33, v118
v_exp_f32 v117, v117
v_fma_f32 v116, v116, v32, v32
v_rcp_f32 v115, v115
s_waitcnt lgkmcnt(6)
v_mfma_f32_32x32x16_bf16 v[80:95], a[224:227], v[128:131], 0
ds_read_b64_tr_b16 a[252:253], v57 offset:28672
ds_read_b64_tr_b16 a[254:255], v57 offset:29184
buffer_load_dwordx4 a[0:3], v1, s[12:15], s38 offen offset:0 sc1
v_mul_f32 v114, v114, v122
v_cvt_pk_bf16_f32 v40, v112, v113
v_mul_f32 v119, v33, v119
v_mfma_f32_32x32x16_bf16 v[80:95], a[228:231], v[132:135], v[80:95]
ds_read_b64_tr_b16 a[224:225], v57 offset:32768
ds_read_b64_tr_b16 a[226:227], v57 offset:33280
v_exp_f32 v118, v118
v_fma_f32 v117, v117, v32, v32
v_mfma_f32_32x32x16_bf16 v[80:95], a[232:235], v[136:139], v[80:95]
ds_read_b64_tr_b16 a[228:229], v57 offset:36864
ds_read_b64_tr_b16 a[230:231], v57 offset:37376
v_rcp_f32 v116, v116
v_mul_f32 v115, v115, v123
v_exp_f32 v119, v119
v_mfma_f32_32x32x16_bf16 v[80:95], a[236:239], v[140:143], v[80:95]
ds_read_b64_tr_b16 a[232:233], v57 offset:40960
ds_read_b64_tr_b16 a[234:235], v57 offset:41472
buffer_load_dwordx4 a[4:7], v1, s[12:15], s38 offen offset:1024 sc1
v_fma_f32 v118, v118, v32, v32
s_waitcnt lgkmcnt(6)
v_mfma_f32_32x32x16_bf16 v[80:95], a[240:243], v[144:147], v[80:95]
ds_read_b64_tr_b16 a[236:237], v57 offset:45056
ds_read_b64_tr_b16 a[238:239], v57 offset:45568
v_rcp_f32 v117, v117
v_mul_f32 v116, v116, v124
v_cvt_pk_bf16_f32 v41, v114, v115
v_mfma_f32_32x32x16_bf16 v[80:95], a[244:247], v[148:151], v[80:95]
ds_read_b64_tr_b16 a[240:241], v57 offset:49152
ds_read_b64_tr_b16 a[242:243], v57 offset:49664
v_fma_f32 v119, v119, v32, v32
v_rcp_f32 v118, v118
v_mul_f32 v117, v117, v125
v_mfma_f32_32x32x16_bf16 v[80:95], a[248:251], v[152:155], v[80:95]
ds_read_b64_tr_b16 a[244:245], v57 offset:53248
ds_read_b64_tr_b16 a[246:247], v57 offset:53760
buffer_load_dwordx4 a[8:11], v1, s[12:15], s38 offen offset:2048 sc1
v_rcp_f32 v119, v119
v_mul_f32 v118, v118, v126
v_mfma_f32_32x32x16_bf16 v[80:95], a[252:255], v[156:159], v[80:95]
ds_read_b64_tr_b16 a[248:249], v57 offset:57344
ds_read_b64_tr_b16 a[250:251], v57 offset:57856
v_cvt_pk_bf16_f32 v42, v116, v117
v_mul_f32 v119, v119, v127
v_cvt_pk_bf16_f32 v43, v118, v119
s_waitcnt lgkmcnt(6)
v_mfma_f32_32x32x16_bf16 v[80:95], a[224:227], v[160:163], v[80:95]
ds_read_b64_tr_b16 a[252:253], v57 offset:61440
ds_read_b64_tr_b16 a[254:255], v57 offset:61952
v_xor_b32 v57, 0x10000, v57
buffer_store_dwordx4 v[40:43], v1, s[12:15], s39 offen sc1
s_add_u32 s39, s39, 93184
v_mfma_f32_32x32x16_bf16 v[80:95], a[228:231], v[164:167], v[80:95]
ds_read_b64_tr_b16 a[224:225], v57 offset:0
ds_read_b64_tr_b16 a[226:227], v57 offset:512
buffer_load_dwordx4 a[12:15], v1, s[12:15], s38 offen offset:3072 sc1
s_add_u32 s38, s38, 4096
v_mul_f32 v64, v31, v64
v_mfma_f32_32x32x16_bf16 v[80:95], a[232:235], v[168:171], v[80:95]
ds_read_b64_tr_b16 a[228:229], v57 offset:4096
ds_read_b64_tr_b16 a[230:231], v57 offset:4608
v_mul_f32 v65, v31, v65
v_exp_f32 v64, v64
v_mfma_f32_32x32x16_bf16 v[80:95], a[236:239], v[172:175], v[80:95]
ds_read_b64_tr_b16 a[232:233], v57 offset:8192
ds_read_b64_tr_b16 a[234:235], v57 offset:8704
v_mul_f32 v66, v31, v66
s_waitcnt lgkmcnt(6)
v_mfma_f32_32x32x16_bf16 v[80:95], a[240:243], v[176:179], v[80:95]
ds_read_b64_tr_b16 a[236:237], v57 offset:12288
ds_read_b64_tr_b16 a[238:239], v57 offset:12800
buffer_load_dwordx4 a[16:19], v1, s[12:15], s38 offen offset:0 sc1
v_exp_f32 v65, v65
v_mfma_f32_32x32x16_bf16 v[80:95], a[244:247], v[180:183], v[80:95]
ds_read_b64_tr_b16 a[240:241], v57 offset:16384
ds_read_b64_tr_b16 a[242:243], v57 offset:16896
v_fma_f32 v64, v64, v30, v30
v_mul_f32 v67, v31, v67
v_exp_f32 v66, v66
v_mfma_f32_32x32x16_bf16 v[80:95], a[248:251], v[184:187], v[80:95]
ds_read_b64_tr_b16 a[244:245], v57 offset:20480
ds_read_b64_tr_b16 a[246:247], v57 offset:20992
v_fma_f32 v65, v65, v30, v30
v_rcp_f32 v64, v64
v_mfma_f32_32x32x16_bf16 v[80:95], a[252:255], v[188:191], v[80:95]
ds_read_b64_tr_b16 a[248:249], v57 offset:24576
ds_read_b64_tr_b16 a[250:251], v57 offset:25088
v_mul_f32 v68, v31, v68
s_waitcnt lgkmcnt(6)
v_mfma_f32_32x32x16_bf16 v[80:95], a[224:227], v[192:195], v[80:95]
ds_read_b64_tr_b16 a[252:253], v57 offset:28672
ds_read_b64_tr_b16 a[254:255], v57 offset:29184
buffer_load_dwordx4 a[20:23], v1, s[12:15], s38 offen offset:1024 sc1
v_exp_f32 v67, v67
v_mfma_f32_32x32x16_bf16 v[80:95], a[228:231], v[196:199], v[80:95]
ds_read_b64_tr_b16 a[224:225], v57 offset:32768
ds_read_b64_tr_b16 a[226:227], v57 offset:33280
v_fma_f32 v66, v66, v30, v30
v_rcp_f32 v65, v65
v_mul_f32 v64, v64, v72
v_mfma_f32_32x32x16_bf16 v[80:95], a[232:235], v[200:203], v[80:95]
ds_read_b64_tr_b16 a[228:229], v57 offset:36864
ds_read_b64_tr_b16 a[230:231], v57 offset:37376
v_mul_f32 v69, v31, v69
v_exp_f32 v68, v68
v_mfma_f32_32x32x16_bf16 v[80:95], a[236:239], v[204:207], v[80:95]
ds_read_b64_tr_b16 a[232:233], v57 offset:40960
ds_read_b64_tr_b16 a[234:235], v57 offset:41472
buffer_load_dwordx4 a[24:27], v1, s[12:15], s38 offen offset:2048 sc1
v_fma_f32 v67, v67, v30, v30
s_waitcnt lgkmcnt(6)
v_mfma_f32_32x32x16_bf16 v[80:95], a[240:243], v[208:211], v[80:95]
ds_read_b64_tr_b16 a[236:237], v57 offset:45056
ds_read_b64_tr_b16 a[238:239], v57 offset:45568
v_rcp_f32 v66, v66
v_mul_f32 v65, v65, v73
v_mfma_f32_32x32x16_bf16 v[80:95], a[244:247], v[212:215], v[80:95]
ds_read_b64_tr_b16 a[240:241], v57 offset:49152
ds_read_b64_tr_b16 a[242:243], v57 offset:49664
v_mul_f32 v70, v31, v70
v_exp_f32 v69, v69
v_fma_f32 v68, v68, v30, v30
v_mfma_f32_32x32x16_bf16 v[80:95], a[248:251], v[216:219], v[80:95]
ds_read_b64_tr_b16 a[244:245], v57 offset:53248
ds_read_b64_tr_b16 a[246:247], v57 offset:53760
buffer_load_dwordx4 a[28:31], v1, s[12:15], s38 offen offset:3072 sc1
s_add_u32 s38, s38, 4096
v_mfma_f32_32x32x16_bf16 v[80:95], a[252:255], v[220:223], v[80:95]
ds_read_b64_tr_b16 a[248:249], v57 offset:57344
ds_read_b64_tr_b16 a[250:251], v57 offset:57856
v_rcp_f32 v67, v67
s_waitcnt lgkmcnt(6)
v_mfma_f32_32x32x16_bf16 v[80:95], a[224:227], v[224:227], v[80:95]
ds_read_b64_tr_b16 a[252:253], v57 offset:61440
ds_read_b64_tr_b16 a[254:255], v57 offset:61952
v_mul_f32 v66, v66, v74
v_cvt_pk_bf16_f32 v40, v64, v65
v_mul_f32 v71, v31, v71
v_mfma_f32_32x32x16_bf16 v[80:95], a[228:231], v[228:231], v[80:95]
ds_read_b64_tr_b16 a[224:225], v2 offset:0
ds_read_b64_tr_b16 a[226:227], v2 offset:512
buffer_load_dwordx4 a[32:35], v1, s[12:15], s38 offen offset:0 sc1
v_exp_f32 v70, v70
v_mfma_f32_32x32x16_bf16 v[80:95], a[232:235], v[232:235], v[80:95]
ds_read_b64_tr_b16 a[228:229], v2 offset:4096
ds_read_b64_tr_b16 a[230:231], v2 offset:4608
v_fma_f32 v69, v69, v30, v30
v_rcp_f32 v68, v68
v_mul_f32 v67, v67, v75
v_mfma_f32_32x32x16_bf16 v[80:95], a[236:239], v[236:239], v[80:95]
ds_read_b64_tr_b16 a[232:233], v2 offset:8192
ds_read_b64_tr_b16 a[234:235], v2 offset:8704
v_exp_f32 v71, v71
s_waitcnt lgkmcnt(6)
v_mfma_f32_32x32x16_bf16 v[80:95], a[240:243], v[240:243], v[80:95]
ds_read_b64_tr_b16 a[236:237], v2 offset:12288
ds_read_b64_tr_b16 a[238:239], v2 offset:12800
buffer_load_dwordx4 a[36:39], v1, s[12:15], s38 offen offset:1024 sc1
v_fma_f32 v70, v70, v30, v30
v_mfma_f32_32x32x16_bf16 v[80:95], a[244:247], v[244:247], v[80:95]
ds_read_b64_tr_b16 a[240:241], v2 offset:16384
ds_read_b64_tr_b16 a[242:243], v2 offset:16896
v_rcp_f32 v69, v69
v_mul_f32 v68, v68, v76
v_mfma_f32_32x32x16_bf16 v[80:95], a[248:251], v[248:251], v[80:95]
ds_read_b64_tr_b16 a[244:245], v2 offset:20480
ds_read_b64_tr_b16 a[246:247], v2 offset:20992
v_cvt_pk_bf16_f32 v41, v66, v67
v_fma_f32 v71, v71, v30, v30
v_rcp_f32 v70, v70
v_mfma_f32_32x32x16_bf16 v[80:95], a[252:255], v[252:255], v[80:95]
ds_read_b64_tr_b16 a[248:249], v2 offset:24576
ds_read_b64_tr_b16 a[250:251], v2 offset:25088
v_mul_f32 v69, v69, v77
v_rcp_f32 v71, v71
v_mfma_f32_32x32x8_bf16 v[80:95], v[18:19], v[28:29], v[80:95]
v_mul_f32 v70, v70, v78
v_cvt_pk_bf16_f32 v42, v68, v69
v_mul_f32 v71, v71, v79
v_cvt_pk_bf16_f32 v43, v70, v71
s_waitcnt lgkmcnt(6)
v_mfma_f32_32x32x16_bf16 v[96:111], a[224:227], v[128:131], 0
ds_read_b64_tr_b16 a[252:253], v2 offset:28672
ds_read_b64_tr_b16 a[254:255], v2 offset:29184
buffer_load_dwordx4 a[40:43], v1, s[12:15], s38 offen offset:2048 sc1
buffer_store_dwordx4 v[40:43], v1, s[12:15], s39 offen sc1
s_add_u32 s39, s39, 7168
v_mfma_f32_32x32x16_bf16 v[96:111], a[228:231], v[132:135], v[96:111]
ds_read_b64_tr_b16 a[224:225], v2 offset:32768
ds_read_b64_tr_b16 a[226:227], v2 offset:33280
v_mfma_f32_32x32x16_bf16 v[96:111], a[232:235], v[136:139], v[96:111]
ds_read_b64_tr_b16 a[228:229], v2 offset:36864
ds_read_b64_tr_b16 a[230:231], v2 offset:37376
v_mul_f32 v80, v31, v80
v_mul_f32 v81, v31, v81
v_mfma_f32_32x32x16_bf16 v[96:111], a[236:239], v[140:143], v[96:111]
ds_read_b64_tr_b16 a[232:233], v2 offset:40960
ds_read_b64_tr_b16 a[234:235], v2 offset:41472
v_exp_f32 v80, v80
s_waitcnt lgkmcnt(6)
v_mfma_f32_32x32x16_bf16 v[96:111], a[240:243], v[144:147], v[96:111]
ds_read_b64_tr_b16 a[236:237], v2 offset:45056
ds_read_b64_tr_b16 a[238:239], v2 offset:45568
v_mul_f32 v82, v31, v82
v_exp_f32 v81, v81
v_mfma_f32_32x32x16_bf16 v[96:111], a[244:247], v[148:151], v[96:111]
ds_read_b64_tr_b16 a[240:241], v2 offset:49152
ds_read_b64_tr_b16 a[242:243], v2 offset:49664
buffer_load_dwordx4 a[44:47], v1, s[12:15], s38 offen offset:3072 sc1
s_add_u32 s38, s38, 4096
v_fma_f32 v80, v80, v30, v30
v_mfma_f32_32x32x16_bf16 v[96:111], a[248:251], v[152:155], v[96:111]
ds_read_b64_tr_b16 a[244:245], v2 offset:53248
ds_read_b64_tr_b16 a[246:247], v2 offset:53760
v_mul_f32 v83, v31, v83
v_exp_f32 v82, v82
v_mfma_f32_32x32x16_bf16 v[96:111], a[252:255], v[156:159], v[96:111]
ds_read_b64_tr_b16 a[248:249], v2 offset:57344
ds_read_b64_tr_b16 a[250:251], v2 offset:57856
v_fma_f32 v81, v81, v30, v30
v_rcp_f32 v80, v80
s_waitcnt lgkmcnt(6)
v_mfma_f32_32x32x16_bf16 v[96:111], a[224:227], v[160:163], v[96:111]
ds_read_b64_tr_b16 a[252:253], v2 offset:61440
ds_read_b64_tr_b16 a[254:255], v2 offset:61952
v_xor_b32 v2, 0x10000, v2
buffer_load_dwordx2 v[38:39], v11, s[12:15], 0 offen offset:0 sc1
v_mul_f32 v84, v31, v84
v_mfma_f32_32x32x16_bf16 v[96:111], a[228:231], v[164:167], v[96:111]
ds_read_b64_tr_b16 a[224:225], v2 offset:0
ds_read_b64_tr_b16 a[226:227], v2 offset:512
v_exp_f32 v83, v83
v_fma_f32 v82, v82, v30, v30
v_mfma_f32_32x32x16_bf16 v[96:111], a[232:235], v[168:171], v[96:111]
ds_read_b64_tr_b16 a[228:229], v2 offset:4096
ds_read_b64_tr_b16 a[230:231], v2 offset:4608
buffer_load_dwordx4 a[48:51], v1, s[12:15], s38 offen offset:0 sc1
v_rcp_f32 v81, v81
v_mfma_f32_32x32x16_bf16 v[96:111], a[236:239], v[172:175], v[96:111]
ds_read_b64_tr_b16 a[232:233], v2 offset:8192
ds_read_b64_tr_b16 a[234:235], v2 offset:8704
v_mul_f32 v80, v80, v88
v_mul_f32 v85, v31, v85
s_waitcnt lgkmcnt(6)
v_mfma_f32_32x32x16_bf16 v[96:111], a[240:243], v[176:179], v[96:111]
ds_read_b64_tr_b16 a[236:237], v2 offset:12288
ds_read_b64_tr_b16 a[238:239], v2 offset:12800
v_exp_f32 v84, v84
v_fma_f32 v83, v83, v30, v30
v_mfma_f32_32x32x16_bf16 v[96:111], a[244:247], v[180:183], v[96:111]
ds_read_b64_tr_b16 a[240:241], v2 offset:16384
ds_read_b64_tr_b16 a[242:243], v2 offset:16896
v_rcp_f32 v82, v82
v_mul_f32 v81, v81, v89
v_mfma_f32_32x32x16_bf16 v[96:111], a[248:251], v[184:187], v[96:111]
ds_read_b64_tr_b16 a[244:245], v2 offset:20480
ds_read_b64_tr_b16 a[246:247], v2 offset:20992
v_mul_f32 v86, v31, v86
v_exp_f32 v85, v85
v_mfma_f32_32x32x16_bf16 v[96:111], a[252:255], v[188:191], v[96:111]
ds_read_b64_tr_b16 a[248:249], v2 offset:24576
ds_read_b64_tr_b16 a[250:251], v2 offset:25088
v_fma_f32 v84, v84, v30, v30
s_waitcnt lgkmcnt(6)
v_mfma_f32_32x32x16_bf16 v[96:111], a[224:227], v[192:195], v[96:111]
ds_read_b64_tr_b16 a[252:253], v2 offset:28672
ds_read_b64_tr_b16 a[254:255], v2 offset:29184
buffer_load_dwordx4 a[52:55], v1, s[12:15], s38 offen offset:1024 sc1
v_rcp_f32 v83, v83
v_mfma_f32_32x32x16_bf16 v[96:111], a[228:231], v[196:199], v[96:111]
ds_read_b64_tr_b16 a[224:225], v2 offset:32768
ds_read_b64_tr_b16 a[226:227], v2 offset:33280
v_mul_f32 v82, v82, v90
v_cvt_pk_bf16_f32 v40, v80, v81
v_mul_f32 v87, v31, v87
v_mfma_f32_32x32x16_bf16 v[96:111], a[232:235], v[200:203], v[96:111]
ds_read_b64_tr_b16 a[228:229], v2 offset:36864
ds_read_b64_tr_b16 a[230:231], v2 offset:37376
v_exp_f32 v86, v86
v_fma_f32 v85, v85, v30, v30
v_mfma_f32_32x32x16_bf16 v[96:111], a[236:239], v[204:207], v[96:111]
ds_read_b64_tr_b16 a[232:233], v2 offset:40960
ds_read_b64_tr_b16 a[234:235], v2 offset:41472
v_rcp_f32 v84, v84
s_waitcnt lgkmcnt(6)
v_mfma_f32_32x32x16_bf16 v[96:111], a[240:243], v[208:211], v[96:111]
ds_read_b64_tr_b16 a[236:237], v2 offset:45056
ds_read_b64_tr_b16 a[238:239], v2 offset:45568
v_mul_f32 v83, v83, v91
v_exp_f32 v87, v87
v_mfma_f32_32x32x16_bf16 v[96:111], a[244:247], v[212:215], v[96:111]
ds_read_b64_tr_b16 a[240:241], v2 offset:49152
ds_read_b64_tr_b16 a[242:243], v2 offset:49664
buffer_load_dwordx4 a[56:59], v1, s[12:15], s38 offen offset:2048 sc1
v_fma_f32 v86, v86, v30, v30
v_mfma_f32_32x32x16_bf16 v[96:111], a[248:251], v[216:219], v[96:111]
ds_read_b64_tr_b16 a[244:245], v2 offset:53248
ds_read_b64_tr_b16 a[246:247], v2 offset:53760
v_rcp_f32 v85, v85
v_mul_f32 v84, v84, v92
v_mfma_f32_32x32x16_bf16 v[96:111], a[252:255], v[220:223], v[96:111]
ds_read_b64_tr_b16 a[248:249], v2 offset:57344
ds_read_b64_tr_b16 a[250:251], v2 offset:57856
v_cvt_pk_bf16_f32 v41, v82, v83
v_fma_f32 v87, v87, v30, v30
s_waitcnt lgkmcnt(6)
v_mfma_f32_32x32x16_bf16 v[96:111], a[224:227], v[224:227], v[96:111]
ds_read_b64_tr_b16 a[252:253], v2 offset:61440
ds_read_b64_tr_b16 a[254:255], v2 offset:61952
v_rcp_f32 v86, v86
v_mul_f32 v85, v85, v93
s_waitcnt vmcnt(5)
buffer_store_dwordx2 v[34:35], v62, s[12:15], 0 offen offset:128 sc1
v_mfma_f32_32x32x16_bf16 v[96:111], a[228:231], v[228:231], v[96:111]
ds_read_b64_tr_b16 a[224:225], v5 offset:0
ds_read_b64_tr_b16 a[226:227], v5 offset:512
v_rcp_f32 v87, v87
v_mul_f32 v86, v86, v94
v_mfma_f32_32x32x16_bf16 v[96:111], a[232:235], v[232:235], v[96:111]
ds_read_b64_tr_b16 a[228:229], v5 offset:4096
ds_read_b64_tr_b16 a[230:231], v5 offset:4608
buffer_load_dwordx4 a[60:63], v1, s[12:15], s38 offen offset:3072 sc1
s_add_u32 s38, s38, 4096
v_cvt_pk_bf16_f32 v42, v84, v85
v_mfma_f32_32x32x16_bf16 v[96:111], a[236:239], v[236:239], v[96:111]
ds_read_b64_tr_b16 a[232:233], v5 offset:8192
ds_read_b64_tr_b16 a[234:235], v5 offset:8704
v_mul_f32 v87, v87, v95
v_cvt_pk_bf16_f32 v43, v86, v87
s_waitcnt lgkmcnt(6)
v_mfma_f32_32x32x16_bf16 v[96:111], a[240:243], v[240:243], v[96:111]
ds_read_b64_tr_b16 a[236:237], v5 offset:12288
ds_read_b64_tr_b16 a[238:239], v5 offset:12800
buffer_store_dwordx4 v[40:43], v1, s[12:15], s39 offen sc1
s_add_u32 s39, s39, 7168
v_mfma_f32_32x32x16_bf16 v[96:111], a[244:247], v[244:247], v[96:111]
ds_read_b64_tr_b16 a[240:241], v5 offset:16384
ds_read_b64_tr_b16 a[242:243], v5 offset:16896
v_mfma_f32_32x32x16_bf16 v[96:111], a[248:251], v[248:251], v[96:111]
ds_read_b64_tr_b16 a[244:245], v5 offset:20480
ds_read_b64_tr_b16 a[246:247], v5 offset:20992
v_mfma_f32_32x32x16_bf16 v[96:111], a[252:255], v[252:255], v[96:111]
ds_read_b64_tr_b16 a[248:249], v5 offset:24576
ds_read_b64_tr_b16 a[250:251], v5 offset:25088
v_mfma_f32_32x32x8_bf16 v[96:111], v[58:59], v[28:29], v[96:111]
s_waitcnt lgkmcnt(6)
v_mfma_f32_32x32x16_bf16 v[112:127], a[224:227], v[128:131], 0
ds_read_b64_tr_b16 a[252:253], v5 offset:28672
ds_read_b64_tr_b16 a[254:255], v5 offset:29184
v_mfma_f32_32x32x16_bf16 v[112:127], a[228:231], v[132:135], v[112:127]
ds_read_b64_tr_b16 a[224:225], v5 offset:32768
ds_read_b64_tr_b16 a[226:227], v5 offset:33280
v_mfma_f32_32x32x16_bf16 v[112:127], a[232:235], v[136:139], v[112:127]
ds_read_b64_tr_b16 a[228:229], v5 offset:36864
ds_read_b64_tr_b16 a[230:231], v5 offset:37376
s_waitcnt vmcnt(6)
v_cmp_eq_u64 vcc, s[82:83], v[38:39]
s_nop 0
s_cmp_eq_u32 vcc_lo, 0x7f
s_cbranch_scc0 L_spin_g0
L_ok_g0:
v_mul_f32 v96, v31, v96
v_mfma_f32_32x32x16_bf16 v[112:127], a[236:239], v[140:143], v[112:127]
ds_read_b64_tr_b16 a[232:233], v5 offset:40960
ds_read_b64_tr_b16 a[234:235], v5 offset:41472
v_mul_f32 v97, v31, v97
v_exp_f32 v96, v96
s_waitcnt lgkmcnt(6)
v_mfma_f32_32x32x16_bf16 v[112:127], a[240:243], v[144:147], v[112:127]
ds_read_b64_tr_b16 a[236:237], v5 offset:45056
ds_read_b64_tr_b16 a[238:239], v5 offset:45568
v_mul_f32 v98, v31, v98
v_exp_f32 v97, v97
v_fma_f32 v96, v96, v30, v30
v_mul_f32 v99, v31, v99
v_mfma_f32_32x32x16_bf16 v[112:127], a[244:247], v[148:151], v[112:127]
ds_read_b64_tr_b16 a[240:241], v5 offset:49152
ds_read_b64_tr_b16 a[242:243], v5 offset:49664
buffer_load_dwordx4 v[128:131], v1, s[12:15], s40 offen offset:0 sc1
v_exp_f32 v98, v98
v_fma_f32 v97, v97, v30, v30
v_mfma_f32_32x32x16_bf16 v[112:127], a[248:251], v[152:155], v[112:127]
ds_read_b64_tr_b16 a[244:245], v5 offset:53248
ds_read_b64_tr_b16 a[246:247], v5 offset:53760
v_rcp_f32 v96, v96
v_mul_f32 v100, v31, v100
v_exp_f32 v99, v99
v_mfma_f32_32x32x16_bf16 v[112:127], a[252:255], v[156:159], v[112:127]
ds_read_b64_tr_b16 a[248:249], v5 offset:57344
ds_read_b64_tr_b16 a[250:251], v5 offset:57856
buffer_load_dwordx4 v[132:135], v1, s[12:15], s40 offen offset:1024 sc1
v_fma_f32 v98, v98, v30, v30
s_waitcnt lgkmcnt(6)
v_mfma_f32_32x32x16_bf16 v[112:127], a[224:227], v[160:163], v[112:127]
ds_read_b64_tr_b16 a[252:253], v5 offset:61440
ds_read_b64_tr_b16 a[254:255], v5 offset:61952
v_xor_b32 v5, 0x10000, v5
v_rcp_f32 v97, v97
v_mul_f32 v96, v96, v104
v_mfma_f32_32x32x16_bf16 v[112:127], a[228:231], v[164:167], v[112:127]
ds_read_b64_tr_b16 a[224:225], v5 offset:0
ds_read_b64_tr_b16 a[226:227], v5 offset:512
buffer_load_dwordx4 v[136:139], v1, s[12:15], s40 offen offset:2048 sc1
v_mul_f32 v101, v31, v101
v_exp_f32 v100, v100
v_fma_f32 v99, v99, v30, v30
v_mfma_f32_32x32x16_bf16 v[112:127], a[232:235], v[168:171], v[112:127]
ds_read_b64_tr_b16 a[228:229], v5 offset:4096
ds_read_b64_tr_b16 a[230:231], v5 offset:4608
v_rcp_f32 v98, v98
v_mul_f32 v97, v97, v105
v_mul_f32 v102, v31, v102
v_mfma_f32_32x32x16_bf16 v[112:127], a[236:239], v[172:175], v[112:127]
ds_read_b64_tr_b16 a[232:233], v5 offset:8192
ds_read_b64_tr_b16 a[234:235], v5 offset:8704
buffer_load_dwordx4 v[140:143], v1, s[12:15], s40 offen offset:3072 sc1
s_add_u32 s40, s40, 4096
v_exp_f32 v101, v101
s_waitcnt lgkmcnt(6)
v_mfma_f32_32x32x16_bf16 v[112:127], a[240:243], v[176:179], v[112:127]
ds_read_b64_tr_b16 a[236:237], v5 offset:12288
ds_read_b64_tr_b16 a[238:239], v5 offset:12800
v_fma_f32 v100, v100, v30, v30
v_rcp_f32 v99, v99
v_mul_f32 v98, v98, v106
v_mfma_f32_32x32x16_bf16 v[112:127], a[244:247], v[180:183], v[112:127]
ds_read_b64_tr_b16 a[240:241], v5 offset:16384
ds_read_b64_tr_b16 a[242:243], v5 offset:16896
buffer_load_dwordx4 v[144:147], v1, s[12:15], s40 offen offset:0 sc1
v_cvt_pk_bf16_f32 v40, v96, v97
v_mul_f32 v103, v31, v103
v_exp_f32 v102, v102
v_mfma_f32_32x32x16_bf16 v[112:127], a[248:251], v[184:187], v[112:127]
ds_read_b64_tr_b16 a[244:245], v5 offset:20480
ds_read_b64_tr_b16 a[246:247], v5 offset:20992
v_fma_f32 v101, v101, v30, v30
v_rcp_f32 v100, v100
v_mul_f32 v99, v99, v107
v_mfma_f32_32x32x16_bf16 v[112:127], a[252:255], v[188:191], v[112:127]
ds_read_b64_tr_b16 a[248:249], v5 offset:24576
ds_read_b64_tr_b16 a[250:251], v5 offset:25088
buffer_load_dwordx4 v[148:151], v1, s[12:15], s40 offen offset:1024 sc1
v_exp_f32 v103, v103
s_waitcnt lgkmcnt(6)
v_mfma_f32_32x32x16_bf16 v[112:127], a[224:227], v[192:195], v[112:127]
ds_read_b64_tr_b16 a[252:253], v5 offset:28672
ds_read_b64_tr_b16 a[254:255], v5 offset:29184
v_fma_f32 v102, v102, v30, v30
v_rcp_f32 v101, v101
v_mul_f32 v100, v100, v108
v_cvt_pk_bf16_f32 v41, v98, v99
v_mfma_f32_32x32x16_bf16 v[112:127], a[228:231], v[196:199], v[112:127]
ds_read_b64_tr_b16 a[224:225], v5 offset:32768
ds_read_b64_tr_b16 a[226:227], v5 offset:33280
buffer_load_dwordx4 v[152:155], v1, s[12:15], s40 offen offset:2048 sc1
v_fma_f32 v103, v103, v30, v30
v_rcp_f32 v102, v102
v_mfma_f32_32x32x16_bf16 v[112:127], a[232:235], v[200:203], v[112:127]
ds_read_b64_tr_b16 a[228:229], v5 offset:36864
ds_read_b64_tr_b16 a[230:231], v5 offset:37376
v_mul_f32 v101, v101, v109
v_rcp_f32 v103, v103
v_mul_f32 v102, v102, v110
v_cvt_pk_bf16_f32 v42, v100, v101
v_mfma_f32_32x32x16_bf16 v[112:127], a[236:239], v[204:207], v[112:127]
ds_read_b64_tr_b16 a[232:233], v5 offset:40960
ds_read_b64_tr_b16 a[234:235], v5 offset:41472
buffer_load_dwordx4 v[156:159], v1, s[12:15], s40 offen offset:3072 sc1
s_add_u32 s40, s40, 4096
v_mul_f32 v103, v103, v111
buffer_load_dwordx2 v[38:39], v11, s[12:15], 0 offen offset:128 sc1
s_waitcnt lgkmcnt(6)
v_mfma_f32_32x32x16_bf16 v[112:127], a[240:243], v[208:211], v[112:127]
ds_read_b64_tr_b16 a[236:237], v5 offset:45056
ds_read_b64_tr_b16 a[238:239], v5 offset:45568
v_cvt_pk_bf16_f32 v43, v102, v103
buffer_store_dwordx4 v[40:43], v1, s[12:15], s39 offen sc1
s_add_u32 s39, s39, 7168
v_mfma_f32_32x32x16_bf16 v[112:127], a[244:247], v[212:215], v[112:127]
ds_read_b64_tr_b16 a[240:241], v5 offset:49152
ds_read_b64_tr_b16 a[242:243], v5 offset:49664
buffer_load_dwordx4 v[160:163], v1, s[12:15], s40 offen offset:0 sc1
v_mfma_f32_32x32x16_bf16 v[112:127], a[248:251], v[216:219], v[112:127]
ds_read_b64_tr_b16 a[244:245], v5 offset:53248
ds_read_b64_tr_b16 a[246:247], v5 offset:53760
v_mfma_f32_32x32x16_bf16 v[112:127], a[252:255], v[220:223], v[112:127]
ds_read_b64_tr_b16 a[248:249], v5 offset:57344
ds_read_b64_tr_b16 a[250:251], v5 offset:57856
buffer_load_dwordx4 v[164:167], v1, s[12:15], s40 offen offset:1024 sc1
s_waitcnt lgkmcnt(6)
v_mfma_f32_32x32x16_bf16 v[112:127], a[224:227], v[224:227], v[112:127]
ds_read_b64_tr_b16 a[252:253], v5 offset:61440
ds_read_b64_tr_b16 a[254:255], v5 offset:61952
v_mfma_f32_32x32x16_bf16 v[112:127], a[228:231], v[228:231], v[112:127]
buffer_load_dwordx4 v[168:171], v1, s[12:15], s40 offen offset:2048 sc1
v_mfma_f32_32x32x16_bf16 v[112:127], a[232:235], v[232:235], v[112:127]
v_mfma_f32_32x32x16_bf16 v[112:127], a[236:239], v[236:239], v[112:127]
buffer_load_dwordx4 v[172:175], v1, s[12:15], s40 offen offset:3072 sc1
s_add_u32 s40, s40, 4096
s_waitcnt lgkmcnt(0)
v_mfma_f32_32x32x16_bf16 v[112:127], a[240:243], v[240:243], v[112:127]
v_mfma_f32_32x32x16_bf16 v[112:127], a[244:247], v[244:247], v[112:127]
buffer_load_dwordx4 v[176:179], v1, s[12:15], s40 offen offset:0 sc1
v_mfma_f32_32x32x16_bf16 v[112:127], a[248:251], v[248:251], v[112:127]
v_mfma_f32_32x32x16_bf16 v[112:127], a[252:255], v[252:255], v[112:127]
buffer_load_dwordx4 v[180:183], v1, s[12:15], s40 offen offset:1024 sc1
v_mfma_f32_32x32x8_bf16 v[112:127], v[60:61], v[28:29], v[112:127]
L_down:
s_waitcnt vmcnt(15)
v_mfma_f32_32x32x16_bf16 a[224:239], a[0:3], v[128:131], 0
v_mfma_f32_32x32x16_bf16 a[240:255], a[4:7], v[128:131], 0
s_waitcnt vmcnt(14)
v_mfma_f32_32x32x16_bf16 a[224:239], a[8:11], v[132:135], a[224:239]
s_nop 6
v_mul_f32 v112, v31, v112
v_mul_f32 v113, v31, v113
v_exp_f32 v112, v112
v_mul_f32 v114, v31, v114
v_mfma_f32_32x32x16_bf16 a[240:255], a[12:15], v[132:135], a[240:255]
v_exp_f32 v113, v113
v_fma_f32 v112, v112, v30, v30
v_mul_f32 v115, v31, v115
s_waitcnt vmcnt(6)
buffer_store_dwordx2 v[34:35], v62, s[12:15], 0 offen offset:256 sc1
v_mfma_f32_32x32x16_bf16 a[224:239], a[16:19], v[136:139], a[224:239]
v_exp_f32 v114, v114
v_fma_f32 v113, v113, v30, v30
v_rcp_f32 v112, v112
v_cmp_eq_u64 vcc, s[82:83], v[38:39]
s_nop 0
s_cmp_eq_u32 vcc_lo, 0x7f
s_cbranch_scc0 L_spin_g1
L_ok_g1:
buffer_load_dwordx4 v[184:187], v1, s[12:15], s40 offen offset:2048 sc1
v_mfma_f32_32x32x16_bf16 a[240:255], a[20:23], v[136:139], a[240:255]
v_mul_f32 v116, v31, v116
v_exp_f32 v115, v115
v_fma_f32 v114, v114, v30, v30
v_mfma_f32_32x32x16_bf16 a[224:239], a[24:27], v[140:143], a[224:239]
v_rcp_f32 v113, v113
v_mul_f32 v112, v112, v120
v_mul_f32 v117, v31, v117
buffer_load_dwordx4 v[188:191], v1, s[12:15], s40 offen offset:3072 sc1
s_add_u32 s40, s40, 4096
v_mfma_f32_32x32x16_bf16 a[240:255], a[28:31], v[140:143], a[240:255]
v_exp_f32 v116, v116
v_fma_f32 v115, v115, v30, v30
v_rcp_f32 v114, v114
v_mfma_f32_32x32x16_bf16 a[224:239], a[32:35], v[144:147], a[224:239]
v_mul_f32 v113, v113, v121
v_mul_f32 v118, v31, v118
v_exp_f32 v117, v117
v_fma_f32 v116, v116, v30, v30
buffer_load_dwordx4 v[192:195], v1, s[12:15], s40 offen offset:0 sc1
v_mfma_f32_32x32x16_bf16 a[240:255], a[36:39], v[144:147], a[240:255]
v_rcp_f32 v115, v115
v_mul_f32 v114, v114, v122
v_cvt_pk_bf16_f32 v40, v112, v113
v_mul_f32 v119, v31, v119
v_mfma_f32_32x32x16_bf16 a[224:239], a[40:43], v[148:151], a[224:239]
v_exp_f32 v118, v118
v_fma_f32 v117, v117, v30, v30
v_rcp_f32 v116, v116
buffer_load_dwordx4 v[196:199], v1, s[12:15], s40 offen offset:1024 sc1
v_mfma_f32_32x32x16_bf16 a[240:255], a[44:47], v[148:151], a[240:255]
v_mul_f32 v115, v115, v123
v_exp_f32 v119, v119
v_fma_f32 v118, v118, v30, v30
v_mfma_f32_32x32x16_bf16 a[224:239], a[48:51], v[152:155], a[224:239]
v_rcp_f32 v117, v117
v_mul_f32 v116, v116, v124
v_cvt_pk_bf16_f32 v41, v114, v115
v_fma_f32 v119, v119, v30, v30
buffer_load_dwordx4 v[200:203], v1, s[12:15], s40 offen offset:2048 sc1
v_mfma_f32_32x32x16_bf16 a[240:255], a[52:55], v[152:155], a[240:255]
v_rcp_f32 v118, v118
v_mul_f32 v117, v117, v125
v_rcp_f32 v119, v119
v_mfma_f32_32x32x16_bf16 a[224:239], a[56:59], v[156:159], a[224:239]
v_mul_f32 v118, v118, v126
v_cvt_pk_bf16_f32 v42, v116, v117
v_mul_f32 v119, v119, v127
v_cvt_pk_bf16_f32 v43, v118, v119
buffer_store_dwordx4 v[40:43], v1, s[12:15], s39 offen sc1
buffer_load_dwordx4 v[204:207], v1, s[12:15], s40 offen offset:3072 sc1
s_add_u32 s40, s40, 4096
v_mfma_f32_32x32x16_bf16 a[240:255], a[60:63], v[156:159], a[240:255]
s_add_u32 s39, s39, 7168
s_waitcnt vmcnt(13)
v_mfma_f32_32x32x16_bf16 a[224:239], a[64:67], v[160:163], a[224:239]
buffer_load_dwordx4 v[208:211], v1, s[12:15], s40 offen offset:0 sc1
v_mfma_f32_32x32x16_bf16 a[240:255], a[68:71], v[160:163], a[240:255]
s_waitcnt vmcnt(13)
v_mfma_f32_32x32x16_bf16 a[224:239], a[72:75], v[164:167], a[224:239]
buffer_load_dwordx4 v[212:215], v1, s[12:15], s40 offen offset:1024 sc1
v_mfma_f32_32x32x16_bf16 a[240:255], a[76:79], v[164:167], a[240:255]
s_waitcnt vmcnt(13)
v_mfma_f32_32x32x16_bf16 a[224:239], a[80:83], v[168:171], a[224:239]
buffer_load_dwordx4 v[216:219], v1, s[12:15], s40 offen offset:2048 sc1
v_mfma_f32_32x32x16_bf16 a[240:255], a[84:87], v[168:171], a[240:255]
s_waitcnt vmcnt(13)
v_mfma_f32_32x32x16_bf16 a[224:239], a[88:91], v[172:175], a[224:239]
buffer_load_dwordx4 v[220:223], v1, s[12:15], s40 offen offset:3072 sc1
s_add_u32 s40, s40, 4096
v_mfma_f32_32x32x16_bf16 a[240:255], a[92:95], v[172:175], a[240:255]
s_waitcnt vmcnt(13)
v_mfma_f32_32x32x16_bf16 a[224:239], a[96:99], v[176:179], a[224:239]
buffer_load_dwordx4 v[224:227], v1, s[12:15], s40 offen offset:0 sc1
v_mfma_f32_32x32x16_bf16 a[240:255], a[100:103], v[176:179], a[240:255]
s_waitcnt vmcnt(13)
v_mfma_f32_32x32x16_bf16 a[224:239], a[104:107], v[180:183], a[224:239]
buffer_load_dwordx4 v[228:231], v1, s[12:15], s40 offen offset:1024 sc1
s_barrier
s_lshl_b32 s3, s28, 10
s_add_u32 s3, s3, 67584
v_add_u32 v56, s3, v1
v_mfma_f32_32x32x16_bf16 a[240:255], a[108:111], v[180:183], a[240:255]
s_waitcnt vmcnt(12)
v_mfma_f32_32x32x16_bf16 a[224:239], a[112:115], v[184:187], a[224:239]
buffer_load_dwordx4 v[232:235], v1, s[12:15], s40 offen offset:2048 sc1
ds_write_b128 v56, v[20:23]
v_mfma_f32_32x32x16_bf16 a[240:255], a[116:119], v[184:187], a[240:255]
s_waitcnt vmcnt(12)
v_mfma_f32_32x32x16_bf16 a[224:239], a[120:123], v[188:191], a[224:239]
buffer_load_dwordx4 v[236:239], v1, s[12:15], s40 offen offset:3072 sc1
s_add_u32 s40, s40, 4096
ds_write_b128 v56, v[24:27] offset:4096
v_mfma_f32_32x32x16_bf16 a[240:255], a[124:127], v[188:191], a[240:255]
s_waitcnt vmcnt(12)
v_mfma_f32_32x32x16_bf16 a[224:239], a[128:131], v[192:195], a[224:239]
buffer_load_dwordx4 v[240:243], v1, s[12:15], s41 offen offset:0 sc1
v_mfma_f32_32x32x16_bf16 a[240:255], a[132:135], v[192:195], a[240:255]
s_waitcnt vmcnt(12)
v_mfma_f32_32x32x16_bf16 a[224:239], a[136:139], v[196:199], a[224:239]
buffer_load_dwordx2 v[38:39], v11, s[12:15], 0 offen offset:256 sc1
buffer_load_dwordx4 v[244:247], v1, s[12:15], s41 offen offset:1024 sc1
v_mfma_f32_32x32x16_bf16 a[240:255], a[140:143], v[196:199], a[240:255]
s_waitcnt vmcnt(13)
v_mfma_f32_32x32x16_bf16 a[224:239], a[144:147], v[200:203], a[224:239]
buffer_load_dwordx4 v[248:251], v1, s[12:15], s41 offen offset:2048 sc1
v_mfma_f32_32x32x16_bf16 a[240:255], a[148:151], v[200:203], a[240:255]
s_waitcnt vmcnt(12)
v_mfma_f32_32x32x16_bf16 a[224:239], a[152:155], v[204:207], a[224:239]
buffer_load_dwordx4 v[252:255], v1, s[12:15], s41 offen offset:3072 sc1
s_add_u32 s41, s41, 4096
v_mfma_f32_32x32x16_bf16 a[240:255], a[156:159], v[204:207], a[240:255]
s_waitcnt vmcnt(12)
v_mfma_f32_32x32x16_bf16 a[224:239], a[160:163], v[208:211], a[224:239]
buffer_store_dwordx2 v[34:35], v62, s[12:15], 0 offen offset:384 sc1
buffer_load_dwordx4 v[128:131], v1, s[12:15], s41 offen offset:0 sc1
v_mfma_f32_32x32x16_bf16 a[240:255], a[164:167], v[208:211], a[240:255]
s_waitcnt vmcnt(13)
v_mfma_f32_32x32x16_bf16 a[224:239], a[168:171], v[212:215], a[224:239]
buffer_load_dwordx4 v[132:135], v1, s[12:15], s41 offen offset:1024 sc1
v_mfma_f32_32x32x16_bf16 a[240:255], a[172:175], v[212:215], a[240:255]
s_waitcnt vmcnt(13)
v_mfma_f32_32x32x16_bf16 a[224:239], a[176:179], v[216:219], a[224:239]
buffer_load_dwordx4 v[136:139], v1, s[12:15], s41 offen offset:2048 sc1
v_mfma_f32_32x32x16_bf16 a[240:255], a[180:183], v[216:219], a[240:255]
s_waitcnt vmcnt(13)
v_mfma_f32_32x32x16_bf16 a[224:239], a[184:187], v[220:223], a[224:239]
v_mfma_f32_32x32x16_bf16 a[240:255], a[188:191], v[220:223], a[240:255]
s_waitcnt vmcnt(12)
v_mfma_f32_32x32x16_bf16 a[224:239], a[192:195], v[224:227], a[224:239]
v_mfma_f32_32x32x16_bf16 a[240:255], a[196:199], v[224:227], a[240:255]
s_waitcnt vmcnt(11)
v_mfma_f32_32x32x16_bf16 a[224:239], a[200:203], v[228:231], a[224:239]
v_mfma_f32_32x32x16_bf16 a[240:255], a[204:207], v[228:231], a[240:255]
s_waitcnt vmcnt(10)
v_mfma_f32_32x32x16_bf16 a[224:239], a[208:211], v[232:235], a[224:239]
s_waitcnt vmcnt(7)
v_cmp_eq_u64 vcc, s[82:83], v[38:39]
s_nop 0
s_cmp_eq_u32 vcc_lo, 0x7f
s_cbranch_scc0 L_spin_g2
L_ok_g2:
buffer_load_dwordx4 v[140:143], v1, s[12:15], s41 offen offset:3072 sc1
s_add_u32 s41, s41, 4096
v_mfma_f32_32x32x16_bf16 a[240:255], a[212:215], v[232:235], a[240:255]
buffer_load_dwordx4 v[144:147], v1, s[12:15], s41 offen offset:0 sc1
v_mfma_f32_32x32x16_bf16 a[224:239], a[216:219], v[236:239], a[224:239]
buffer_load_dwordx4 v[148:151], v1, s[12:15], s41 offen offset:1024 sc1
v_mfma_f32_32x32x16_bf16 a[240:255], a[220:223], v[236:239], a[240:255]
buffer_load_dwordx4 v[152:155], v1, s[12:15], s41 offen offset:2048 sc1
v_mfma_f32_32x32x16_bf16 v[64:79], a[0:3], v[240:243], 0
buffer_load_dwordx4 v[156:159], v1, s[12:15], s41 offen offset:3072 sc1
s_add_u32 s41, s41, 4096
v_mfma_f32_32x32x16_bf16 v[80:95], a[4:7], v[240:243], 0
buffer_load_dwordx4 v[160:163], v1, s[12:15], s41 offen offset:0 sc1
s_waitcnt vmcnt(12)
v_mfma_f32_32x32x16_bf16 v[64:79], a[8:11], v[244:247], v[64:79]
buffer_load_dwordx4 v[164:167], v1, s[12:15], s41 offen offset:1024 sc1
v_mfma_f32_32x32x16_bf16 v[80:95], a[12:15], v[244:247], v[80:95]
ds_write_b128 v3, a[224:227] offset:0
s_waitcnt vmcnt(12)
v_mfma_f32_32x32x16_bf16 v[64:79], a[16:19], v[248:251], v[64:79]
buffer_load_dwordx4 v[168:171], v1, s[12:15], s41 offen offset:2048 sc1
v_mfma_f32_32x32x16_bf16 v[80:95], a[20:23], v[248:251], v[80:95]
ds_write_b128 v3, a[228:231] offset:1056
s_waitcnt vmcnt(12)
v_mfma_f32_32x32x16_bf16 v[64:79], a[24:27], v[252:255], v[64:79]
buffer_load_dwordx4 v[172:175], v1, s[12:15], s41 offen offset:3072 sc1
s_add_u32 s41, s41, 4096
v_mfma_f32_32x32x16_bf16 v[80:95], a[28:31], v[252:255], v[80:95]
ds_write_b128 v3, a[232:235] offset:2112
s_waitcnt vmcnt(11)
v_mfma_f32_32x32x16_bf16 v[64:79], a[32:35], v[128:131], v[64:79]
buffer_load_dwordx4 v[176:179], v1, s[12:15], s41 offen offset:0 sc1
v_mfma_f32_32x32x16_bf16 v[80:95], a[36:39], v[128:131], v[80:95]
ds_write_b128 v3, a[236:239] offset:3168
s_waitcnt vmcnt(11)
v_mfma_f32_32x32x16_bf16 v[64:79], a[40:43], v[132:135], v[64:79]
buffer_load_dwordx4 v[180:183], v1, s[12:15], s41 offen offset:1024 sc1
v_mfma_f32_32x32x16_bf16 v[80:95], a[44:47], v[132:135], v[80:95]
ds_write_b128 v3, a[240:243] offset:4224
s_waitcnt vmcnt(11)
v_mfma_f32_32x32x16_bf16 v[64:79], a[48:51], v[136:139], v[64:79]
buffer_load_dwordx2 v[38:39], v11, s[12:15], 0 offen offset:384 sc1
buffer_load_dwordx4 v[184:187], v1, s[12:15], s41 offen offset:2048 sc1
v_mfma_f32_32x32x16_bf16 v[80:95], a[52:55], v[136:139], v[80:95]
ds_write_b128 v3, a[244:247] offset:5280
s_waitcnt vmcnt(12)
v_mfma_f32_32x32x16_bf16 v[64:79], a[56:59], v[140:143], v[64:79]
buffer_load_dwordx4 v[188:191], v1, s[12:15], s41 offen offset:3072 sc1
s_add_u32 s41, s41, 4096
v_mfma_f32_32x32x16_bf16 v[80:95], a[60:63], v[140:143], v[80:95]
ds_write_b128 v3, a[248:251] offset:6336
s_waitcnt vmcnt(12)
v_mfma_f32_32x32x16_bf16 v[64:79], a[64:67], v[144:147], v[64:79]
buffer_load_dwordx4 v[192:195], v1, s[12:15], s41 offen offset:0 sc1
v_mfma_f32_32x32x16_bf16 v[80:95], a[68:71], v[144:147], v[80:95]
ds_write_b128 v3, a[252:255] offset:7392
s_waitcnt vmcnt(12)
v_mfma_f32_32x32x16_bf16 v[64:79], a[72:75], v[148:151], v[64:79]
v_mfma_f32_32x32x16_bf16 v[80:95], a[76:79], v[148:151], v[80:95]
s_waitcnt vmcnt(11)
v_mfma_f32_32x32x16_bf16 v[64:79], a[80:83], v[152:155], v[64:79]
v_mfma_f32_32x32x16_bf16 v[80:95], a[84:87], v[152:155], v[80:95]
s_waitcnt lgkmcnt(0)
s_barrier
ds_read_b128 v[20:23], v63
ds_read_b128 v[24:27], v63 offset:4096
s_waitcnt vmcnt(10)
v_mfma_f32_32x32x16_bf16 v[64:79], a[88:91], v[156:159], v[64:79]
ds_read_b128 v[96:99], v4 offset:0
ds_read_b128 v[100:103], v4 offset:1056
v_mfma_f32_32x32x16_bf16 v[80:95], a[92:95], v[156:159], v[80:95]
ds_read_b128 v[104:107], v4 offset:8448
ds_read_b128 v[108:111], v4 offset:9504
s_waitcnt vmcnt(9)
v_mfma_f32_32x32x16_bf16 v[64:79], a[96:99], v[160:163], v[64:79]
ds_read_b128 v[112:115], v4 offset:16896
ds_read_b128 v[116:119], v4 offset:17952
v_mfma_f32_32x32x16_bf16 v[80:95], a[100:103], v[160:163], v[80:95]
ds_read_b128 v[120:123], v4 offset:25344
ds_read_b128 v[124:127], v4 offset:26400
s_waitcnt vmcnt(8)
v_mfma_f32_32x32x16_bf16 v[64:79], a[104:107], v[164:167], v[64:79]
v_mfma_f32_32x32x16_bf16 v[80:95], a[108:111], v[164:167], v[80:95]
s_waitcnt lgkmcnt(9)
v_lshlrev_b32 v40, 16, v20
v_and_b32 v41, 0xffff0000, v20
v_lshlrev_b32 v42, 16, v21
v_and_b32 v43, 0xffff0000, v21
s_waitcnt vmcnt(7)
v_mfma_f32_32x32x16_bf16 v[64:79], a[112:115], v[168:171], v[64:79]
v_lshlrev_b32 v44, 16, v22
v_and_b32 v45, 0xffff0000, v22
v_lshlrev_b32 v46, 16, v23
v_and_b32 v47, 0xffff0000, v23
v_mfma_f32_32x32x16_bf16 v[80:95], a[116:119], v[168:171], v[80:95]
s_waitcnt lgkmcnt(7)
v_add_f32 v40, v40, v96
v_add_f32 v41, v41, v97
v_add_f32 v42, v42, v98
v_add_f32 v43, v43, v99
s_waitcnt vmcnt(6)
v_mfma_f32_32x32x16_bf16 v[64:79], a[120:123], v[172:175], v[64:79]
s_waitcnt vmcnt(3)
v_cmp_eq_u64 vcc, s[82:83], v[38:39]
s_nop 0
s_cmp_eq_u32 vcc_lo, 0x7f
s_cbranch_scc0 L_spin_g3
L_ok_g3:
buffer_load_dwordx4 v[196:199], v1, s[12:15], s41 offen offset:1024 sc1
s_waitcnt lgkmcnt(6)
v_add_f32 v44, v44, v100
v_mfma_f32_32x32x16_bf16 v[80:95], a[124:127], v[172:175], v[80:95]
buffer_load_dwordx4 v[200:203], v1, s[12:15], s41 offen offset:2048 sc1
v_add_f32 v45, v45, v101
v_add_f32 v46, v46, v102
v_add_f32 v47, v47, v103
s_waitcnt lgkmcnt(5)
v_add_f32 v40, v40, v104
v_mfma_f32_32x32x16_bf16 v[64:79], a[128:131], v[176:179], v[64:79]
buffer_load_dwordx4 v[204:207], v1, s[12:15], s41 offen offset:3072 sc1
s_add_u32 s41, s41, 4096
v_add_f32 v41, v41, v105
v_add_f32 v42, v42, v106
v_add_f32 v43, v43, v107
v_mfma_f32_32x32x16_bf16 v[80:95], a[132:135], v[176:179], v[80:95]
buffer_load_dwordx4 v[208:211], v1, s[12:15], s41 offen offset:0 sc1
s_waitcnt lgkmcnt(4)
v_add_f32 v44, v44, v108
v_add_f32 v45, v45, v109
v_add_f32 v46, v46, v110
v_add_f32 v47, v47, v111
v_mfma_f32_32x32x16_bf16 v[64:79], a[136:139], v[180:183], v[64:79]
buffer_load_dwordx4 v[212:215], v1, s[12:15], s41 offen offset:1024 sc1
s_waitcnt lgkmcnt(3)
v_add_f32 v40, v40, v112
v_add_f32 v41, v41, v113
v_add_f32 v42, v42, v114
v_add_f32 v43, v43, v115
v_mfma_f32_32x32x16_bf16 v[80:95], a[140:143], v[180:183], v[80:95]
buffer_load_dwordx4 v[216:219], v1, s[12:15], s41 offen offset:2048 sc1
s_waitcnt lgkmcnt(2)
v_add_f32 v44, v44, v116
v_add_f32 v45, v45, v117
v_add_f32 v46, v46, v118
v_add_f32 v47, v47, v119
s_waitcnt vmcnt(8)
v_mfma_f32_32x32x16_bf16 v[64:79], a[144:147], v[184:187], v[64:79]
buffer_load_dwordx4 v[220:223], v1, s[12:15], s41 offen offset:3072 sc1
s_add_u32 s41, s41, 4096
s_waitcnt lgkmcnt(1)
v_add_f32 v40, v40, v120
v_add_f32 v41, v41, v121
v_add_f32 v42, v42, v122
v_mfma_f32_32x32x16_bf16 v[80:95], a[148:151], v[184:187], v[80:95]
v_add_f32 v43, v43, v123
s_waitcnt lgkmcnt(0)
v_add_f32 v44, v44, v124
v_add_f32 v45, v45, v125
v_add_f32 v46, v46, v126
s_waitcnt vmcnt(8)
v_mfma_f32_32x32x16_bf16 v[64:79], a[152:155], v[188:191], v[64:79]
v_add_f32 v47, v47, v127
v_cvt_pk_bf16_f32 v40, v40, v41
v_cvt_pk_bf16_f32 v41, v42, v43
v_cvt_pk_bf16_f32 v42, v44, v45
v_mfma_f32_32x32x16_bf16 v[80:95], a[156:159], v[188:191], v[80:95]
v_cvt_pk_bf16_f32 v43, v46, v47
v_lshlrev_b32 v48, 16, v24
v_and_b32 v49, 0xffff0000, v24
v_lshlrev_b32 v50, 16, v25
s_waitcnt vmcnt(7)
v_mfma_f32_32x32x16_bf16 v[64:79], a[160:163], v[192:195], v[64:79]
v_and_b32 v51, 0xffff0000, v25
v_lshlrev_b32 v52, 16, v26
v_and_b32 v53, 0xffff0000, v26
v_lshlrev_b32 v54, 16, v27
v_mfma_f32_32x32x16_bf16 v[80:95], a[164:167], v[192:195], v[80:95]
v_and_b32 v55, 0xffff0000, v27
s_waitcnt vmcnt(6)
v_mfma_f32_32x32x16_bf16 v[64:79], a[168:171], v[196:199], v[64:79]
s_waitcnt vmcnt(5)
v_mfma_f32_32x32x16_bf16 v[64:79], a[176:179], v[200:203], v[64:79]
s_waitcnt vmcnt(4)
v_mfma_f32_32x32x16_bf16 v[64:79], a[184:187], v[204:207], v[64:79]
s_waitcnt vmcnt(3)
v_mfma_f32_32x32x16_bf16 v[64:79], a[192:195], v[208:211], v[64:79]
s_waitcnt vmcnt(2)
v_mfma_f32_32x32x16_bf16 v[64:79], a[200:203], v[212:215], v[64:79]
s_waitcnt vmcnt(1)
v_mfma_f32_32x32x16_bf16 v[64:79], a[208:211], v[216:219], v[64:79]
s_waitcnt vmcnt(0)
v_mfma_f32_32x32x16_bf16 v[64:79], a[216:219], v[220:223], v[64:79]
global_store_dwordx4 v12, v[40:43], s[18:19] sc1
v_add_u32 v12, 0x8000, v12
v_mfma_f32_32x32x16_bf16 v[80:95], a[172:175], v[196:199], v[80:95]
v_mfma_f32_32x32x16_bf16 v[80:95], a[180:183], v[200:203], v[80:95]
s_nop 7
ds_write_b128 v3, v[64:67] offset:33792
v_mfma_f32_32x32x16_bf16 v[80:95], a[188:191], v[204:207], v[80:95]
ds_write_b128 v3, v[68:71] offset:34848
v_mfma_f32_32x32x16_bf16 v[80:95], a[196:199], v[208:211], v[80:95]
ds_write_b128 v3, v[72:75] offset:35904
v_mfma_f32_32x32x16_bf16 v[80:95], a[204:207], v[212:215], v[80:95]
ds_write_b128 v3, v[76:79] offset:36960
v_mfma_f32_32x32x16_bf16 v[80:95], a[212:215], v[216:219], v[80:95]
v_mfma_f32_32x32x16_bf16 v[80:95], a[220:223], v[220:223], v[80:95]
s_nop 11
ds_write_b128 v3, v[80:83] offset:38016
ds_write_b128 v3, v[84:87] offset:39072
ds_write_b128 v3, v[88:91] offset:40128
ds_write_b128 v3, v[92:95] offset:41184
s_waitcnt lgkmcnt(0)
s_barrier
ds_read_b128 v[128:131], v4 offset:33792
ds_read_b128 v[132:135], v4 offset:34848
ds_read_b128 v[136:139], v4 offset:42240
ds_read_b128 v[140:143], v4 offset:43296
ds_read_b128 v[144:147], v4 offset:50688
ds_read_b128 v[148:151], v4 offset:51744
ds_read_b128 v[152:155], v4 offset:59136
ds_read_b128 v[156:159], v4 offset:60192
s_waitcnt lgkmcnt(7)
v_pk_add_f32 v[48:49], v[48:49], v[128:129]
v_pk_add_f32 v[50:51], v[50:51], v[130:131]
s_waitcnt lgkmcnt(6)
v_pk_add_f32 v[52:53], v[52:53], v[132:133]
v_pk_add_f32 v[54:55], v[54:55], v[134:135]
s_waitcnt lgkmcnt(5)
v_pk_add_f32 v[48:49], v[48:49], v[136:137]
v_pk_add_f32 v[50:51], v[50:51], v[138:139]
s_waitcnt lgkmcnt(4)
v_pk_add_f32 v[52:53], v[52:53], v[140:141]
v_pk_add_f32 v[54:55], v[54:55], v[142:143]
s_waitcnt lgkmcnt(3)
v_pk_add_f32 v[48:49], v[48:49], v[144:145]
v_pk_add_f32 v[50:51], v[50:51], v[146:147]
s_waitcnt lgkmcnt(2)
v_pk_add_f32 v[52:53], v[52:53], v[148:149]
v_pk_add_f32 v[54:55], v[54:55], v[150:151]
s_waitcnt lgkmcnt(1)
v_pk_add_f32 v[48:49], v[48:49], v[152:153]
v_pk_add_f32 v[50:51], v[50:51], v[154:155]
s_waitcnt lgkmcnt(0)
v_pk_add_f32 v[52:53], v[52:53], v[156:157]
v_pk_add_f32 v[54:55], v[54:55], v[158:159]
v_cvt_pk_bf16_f32 v48, v48, v49
v_cvt_pk_bf16_f32 v49, v50, v51
v_cvt_pk_bf16_f32 v50, v52, v53
v_cvt_pk_bf16_f32 v51, v54, v55
global_store_dwordx4 v12, v[48:51], s[18:19] sc1
L_end:
s_endpgm
L_res0:
ds_read_b64 a[124:125], v63 offset:0
ds_read_b64 a[126:127], v63 offset:4096
ds_read_b64 a[128:129], v63 offset:8192
ds_read_b64 a[130:131], v63 offset:12288
s_waitcnt lgkmcnt(0)
s_branch L_resb0
L_res1:
ds_read_b64 a[124:125], v63 offset:16384
ds_read_b64 a[126:127], v63 offset:20480
ds_read_b64 a[128:129], v63 offset:24576
ds_read_b64 a[130:131], v63 offset:28672
s_waitcnt lgkmcnt(0)
s_branch L_resb1
L_res2:
ds_read_b64 a[124:125], v63 offset:32768
ds_read_b64 a[126:127], v63 offset:36864
ds_read_b64 a[128:129], v63 offset:40960
ds_read_b64 a[130:131], v63 offset:45056
s_waitcnt lgkmcnt(0)
s_branch L_resb2
L_res3:
ds_read_b64 a[124:125], v63 offset:49152
ds_read_b64 a[126:127], v63 offset:53248
ds_read_b64 a[128:129], v63 offset:57344
ds_read_b64 a[130:131], v63 offset:61440
s_waitcnt lgkmcnt(0)
s_branch L_resb3
L_res4:
ds_read_b64 a[124:125], v63 offset:0
ds_read_b64 a[126:127], v63 offset:4096
ds_read_b64 a[128:129], v63 offset:8192
ds_read_b64 a[130:131], v63 offset:12288
s_waitcnt lgkmcnt(0)
s_branch L_resb4
L_res5:
ds_read_b64 a[124:125], v63 offset:16384
ds_read_b64 a[126:127], v63 offset:20480
ds_read_b64 a[128:129], v63 offset:24576
ds_read_b64 a[130:131], v63 offset:28672
s_waitcnt lgkmcnt(0)
s_branch L_resb5
L_res6:
ds_read_b64 a[124:125], v63 offset:32768
ds_read_b64 a[126:127], v63 offset:36864
ds_read_b64 a[128:129], v63 offset:40960
ds_read_b64 a[130:131], v63 offset:45056
s_waitcnt lgkmcnt(0)
s_branch L_resb6
L_res7:
ds_read_b64 a[124:125], v63 offset:49152
ds_read_b64 a[126:127], v63 offset:53248
ds_read_b64 a[128:129], v63 offset:57344
ds_read_b64 a[130:131], v63 offset:61440
s_waitcnt lgkmcnt(0)
s_branch L_resb7
L_spin_non:
s_mov_b64 exec, 1
s_add_u32 s37, s37, 1
global_load_dwordx2 v[34:35], v1, s[18:19] sc1
s_mov_b64 exec, -1
s_cmp_gt_u32 s37, 0x20000
s_cbranch_scc1 L_end
s_waitcnt vmcnt(0)
v_readfirstlane_b32 s83, v35
v_readfirstlane_b32 s82, v34
s_nop 1
s_cmp_lg_u32 s83, 0
s_cbranch_scc0 L_spin_non
s_branch L_ok_non
L_spin_k:
buffer_load_dwordx2 v[38:39], v248, s[12:15], 0 offen offset:0 sc1
s_add_u32 s37, s37, 1
s_cmp_gt_u32 s37, 0x20000
s_cbranch_scc1 L_end
s_waitcnt vmcnt(0)
v_cmp_eq_u64 vcc, s[82:83], v[38:39]
s_nop 1
s_cmp_eq_u32 vcc_lo, 0xf
s_cbranch_scc0 L_spin_k
s_branch L_ok_k
L_spin_v:
buffer_load_dwordx2 v[38:39], v248, s[12:15], 0 offen offset:128 sc1
s_add_u32 s37, s37, 1
s_cmp_gt_u32 s37, 0x20000
s_cbranch_scc1 L_end
s_waitcnt vmcnt(0)
v_cmp_eq_u64 vcc, s[82:83], v[38:39]
s_nop 1
s_cmp_eq_u32 vcc_lo, 0xf
s_cbranch_scc0 L_spin_v
s_branch L_ok_v
L_spin_oa:
buffer_load_dwordx2 v[38:39], v2, s[12:15], 0 offen offset:384 sc1
s_add_u32 s37, s37, 1
s_cmp_gt_u32 s37, 0x20000
s_cbranch_scc1 L_end
s_waitcnt vmcnt(0)
v_cmp_eq_u64 vcc, s[82:83], v[38:39]
s_nop 1
s_cmp_eq_u32 vcc_lo, 0x3
s_cbranch_scc0 L_spin_oa
s_branch L_ok_oa
L_spin_ob:
buffer_load_dwordx2 v[38:39], v2, s[12:15], 0 offen offset:512 sc1
s_add_u32 s37, s37, 1
s_cmp_gt_u32 s37, 0x20000
s_cbranch_scc1 L_end
s_waitcnt vmcnt(0)
v_cmp_eq_u64 vcc, s[82:83], v[38:39]
s_nop 1
s_cmp_eq_u32 vcc_lo, 0x3
s_cbranch_scc0 L_spin_ob
s_branch L_ok_ob
L_spin_d:
buffer_load_dwordx2 v[28:29], v59, s[12:15], 0 offen offset:896 sc1
s_add_u32 s37, s37, 1
s_cmp_gt_u32 s37, 0x20000
s_cbranch_scc1 L_end
s_waitcnt vmcnt(0)
v_cmp_eq_u64 vcc, s[82:83], v[28:29]
s_nop 1
s_cmp_eq_u32 vcc_lo, 0x7f
s_cbranch_scc0 L_spin_d
s_branch L_ok_d
L_spin_h:
buffer_load_dwordx2 v[38:39], v7, s[12:15], 0 offen offset:640 sc1
s_add_u32 s37, s37, 1
s_cmp_gt_u32 s37, 0x20000
s_cbranch_scc1 L_end
s_waitcnt vmcnt(0)
v_cmp_eq_u64 vcc, s[82:83], v[38:39]
s_nop 1
s_cmp_eq_u32 vcc_lo, 0xff
s_cbranch_scc0 L_spin_h
s_branch L_ok_h
L_idle:
s_waitcnt vmcnt(0)
s_barrier
buffer_store_dwordx2 v[34:35], v36, s[12:15], 0 offen offset:768 sc1
buffer_load_dwordx4 a[128:131], v1, s[12:15], s38 offen offset:0 sc1
buffer_load_dwordx4 a[132:135], v1, s[12:15], s38 offen offset:1024 sc1
buffer_load_dwordx4 a[136:139], v1, s[12:15], s38 offen offset:2048 sc1
buffer_load_dwordx4 a[140:143], v1, s[12:15], s38 offen offset:3072 sc1
s_add_u32 s38, s38, 4096
buffer_load_dwordx4 a[144:147], v1, s[12:15], s38 offen offset:0 sc1
buffer_load_dwordx4 a[148:151], v1, s[12:15], s38 offen offset:1024 sc1
buffer_load_dwordx4 a[152:155], v1, s[12:15], s38 offen offset:2048 sc1
buffer_load_dwordx4 a[156:159], v1, s[12:15], s38 offen offset:3072 sc1
s_add_u32 s38, s38, 4096
buffer_load_dwordx4 a[160:163], v1, s[12:15], s38 offen offset:0 sc1
buffer_load_dwordx4 a[164:167], v1, s[12:15], s38 offen offset:1024 sc1
buffer_load_dwordx4 a[168:171], v1, s[12:15], s38 offen offset:2048 sc1
buffer_load_dwordx4 a[172:175], v1, s[12:15], s38 offen offset:3072 sc1
s_add_u32 s38, s38, 4096
buffer_load_dwordx4 a[176:179], v1, s[12:15], s38 offen offset:0 sc1
buffer_load_dwordx4 a[180:183], v1, s[12:15], s38 offen offset:1024 sc1
buffer_load_dwordx4 a[184:187], v1, s[12:15], s38 offen offset:2048 sc1
buffer_load_dwordx4 a[188:191], v1, s[12:15], s38 offen offset:3072 sc1
s_add_u32 s38, s38, 4096
buffer_load_dwordx4 a[192:195], v1, s[12:15], s38 offen offset:0 sc1
buffer_load_dwordx4 a[196:199], v1, s[12:15], s38 offen offset:1024 sc1
buffer_load_dwordx4 a[200:203], v1, s[12:15], s38 offen offset:2048 sc1
buffer_load_dwordx4 a[204:207], v1, s[12:15], s38 offen offset:3072 sc1
s_add_u32 s38, s38, 4096
v_lshlrev_b32 v65, 3, v1
buffer_load_dwordx4 a[208:211], v1, s[12:15], s38 offen offset:0 sc1
buffer_load_dwordx4 a[212:215], v1, s[12:15], s38 offen offset:1024 sc1
buffer_load_dwordx4 a[216:219], v1, s[12:15], s38 offen offset:2048 sc1
buffer_load_dwordx4 a[220:223], v1, s[12:15], s38 offen offset:3072 sc1
s_sub_u32 s38, s38, 53248
buffer_load_dwordx4 a[0:3], v1, s[12:15], s38 offen offset:0 sc1
buffer_load_dwordx4 a[4:7], v1, s[12:15], s38 offen offset:1024 sc1
buffer_load_dwordx4 a[8:11], v1, s[12:15], s38 offen offset:2048 sc1
buffer_load_dwordx4 a[12:15], v1, s[12:15], s38 offen offset:3072 sc1
s_add_u32 s38, s38, 4096
buffer_load_dwordx4 a[16:19], v1, s[12:15], s38 offen offset:0 sc1
buffer_load_dwordx4 a[20:23], v1, s[12:15], s38 offen offset:1024 sc1
buffer_load_dwordx4 a[24:27], v1, s[12:15], s38 offen offset:2048 sc1
buffer_load_dwordx4 a[28:31], v1, s[12:15], s38 offen offset:3072 sc1
s_add_u32 s38, s38, 4096
buffer_load_dwordx4 a[32:35], v1, s[12:15], s38 offen offset:0 sc1
buffer_load_dwordx4 a[36:39], v1, s[12:15], s38 offen offset:1024 sc1
buffer_load_dwordx4 a[40:43], v1, s[12:15], s38 offen offset:2048 sc1
buffer_load_dwordx4 a[44:47], v1, s[12:15], s38 offen offset:3072 sc1
s_add_u32 s38, s38, 4096
buffer_load_dwordx4 a[48:51], v1, s[12:15], s38 offen offset:0 sc1
buffer_load_dwordx4 a[52:55], v1, s[12:15], s38 offen offset:1024 sc1
buffer_load_dwordx4 a[56:59], v1, s[12:15], s38 offen offset:2048 sc1
buffer_load_dwordx4 a[60:63], v1, s[12:15], s38 offen offset:3072 sc1
s_add_u32 s38, s38, 4096
L_idle1:
s_sleep 8
buffer_load_dwordx2 v[38:39], v11, s[12:15], 0 offen offset:0 sc1
s_add_u32 s37, s37, 1
s_cmp_gt_u32 s37, 0x20000
s_cbranch_scc1 L_end
s_waitcnt vmcnt(0)
v_cmp_eq_u64 vcc, s[82:83], v[38:39]
s_nop 1
s_cmp_eq_u32 vcc_lo, 0x7f
s_cbranch_scc0 L_idle1
buffer_load_dwordx4 v[128:131], v1, s[12:15], s40 offen offset:0 sc1
buffer_load_dwordx4 v[132:135], v1, s[12:15], s40 offen offset:1024 sc1
buffer_load_dwordx4 v[136:139], v1, s[12:15], s40 offen offset:2048 sc1
buffer_load_dwordx4 v[140:143], v1, s[12:15], s40 offen offset:3072 sc1
s_add_u32 s40, s40, 4096
buffer_load_dwordx4 v[144:147], v1, s[12:15], s40 offen offset:0 sc1
buffer_load_dwordx4 v[148:151], v1, s[12:15], s40 offen offset:1024 sc1
buffer_load_dwordx4 v[152:155], v1, s[12:15], s40 offen offset:2048 sc1
buffer_load_dwordx4 v[156:159], v1, s[12:15], s40 offen offset:3072 sc1
s_add_u32 s40, s40, 4096
buffer_load_dwordx4 v[160:163], v1, s[12:15], s40 offen offset:0 sc1
buffer_load_dwordx4 v[164:167], v1, s[12:15], s40 offen offset:1024 sc1
buffer_load_dwordx4 v[168:171], v1, s[12:15], s40 offen offset:2048 sc1
buffer_load_dwordx4 v[172:175], v1, s[12:15], s40 offen offset:3072 sc1
s_add_u32 s40, s40, 4096
buffer_load_dwordx4 v[176:179], v1, s[12:15], s40 offen offset:0 sc1
buffer_load_dwordx4 v[180:183], v1, s[12:15], s40 offen offset:1024 sc1
L_idle2:
s_sleep 8
buffer_load_dwordx2 v[38:39], v11, s[12:15], 0 offen offset:128 sc1
s_add_u32 s37, s37, 1
s_cmp_gt_u32 s37, 0x20000
s_cbranch_scc1 L_end
s_waitcnt vmcnt(0)
v_cmp_eq_u64 vcc, s[82:83], v[38:39]
s_nop 1
s_cmp_eq_u32 vcc_lo, 0x7f
s_cbranch_scc0 L_idle2
s_branch L_down
L_spin_hb:
buffer_load_dwordx2 v[38:39], v7, s[12:15], 0 offen offset:768 sc1
s_add_u32 s37, s37, 1
s_cmp_gt_u32 s37, 0x20000
s_cbranch_scc1 L_end
s_waitcnt vmcnt(0)
v_cmp_eq_u64 vcc, s[82:83], v[38:39]
s_nop 1
s_cmp_eq_u32 vcc_lo, 0xff
s_cbranch_scc0 L_spin_hb
s_branch L_ok_hb
L_spin_g0:
buffer_load_dwordx2 v[38:39], v11, s[12:15], 0 offen offset:0 sc1
s_add_u32 s37, s37, 1
s_cmp_gt_u32 s37, 0x20000
s_cbranch_scc1 L_end
s_waitcnt vmcnt(0)
v_cmp_eq_u64 vcc, s[82:83], v[38:39]
s_nop 1
s_cmp_eq_u32 vcc_lo, 0x7f
s_cbranch_scc0 L_spin_g0
s_branch L_ok_g0
L_spin_g1:
buffer_load_dwordx2 v[38:39], v11, s[12:15], 0 offen offset:128 sc1
s_add_u32 s37, s37, 1
s_cmp_gt_u32 s37, 0x20000
s_cbranch_scc1 L_end
s_waitcnt vmcnt(0)
v_cmp_eq_u64 vcc, s[82:83], v[38:39]
s_nop 1
s_cmp_eq_u32 vcc_lo, 0x7f
s_cbranch_scc0 L_spin_g1
s_branch L_ok_g1
L_spin_g2:
buffer_load_dwordx2 v[38:39], v11, s[12:15], 0 offen offset:256 sc1
s_add_u32 s37, s37, 1
s_cmp_gt_u32 s37, 0x20000
s_cbranch_scc1 L_end
s_waitcnt vmcnt(0)
v_cmp_eq_u64 vcc, s[82:83], v[38:39]
s_nop 1
s_cmp_eq_u32 vcc_lo, 0x7f
s_cbranch_scc0 L_spin_g2
s_branch L_ok_g2
L_spin_g3:
buffer_load_dwordx2 v[38:39], v11, s[12:15], 0 offen offset:384 sc1
s_add_u32 s37, s37, 1
s_cmp_gt_u32 s37, 0x20000
s_cbranch_scc1 L_end
s_waitcnt vmcnt(0)
v_cmp_eq_u64 vcc, s[82:83], v[38:39]
s_nop 1
s_cmp_eq_u32 vcc_lo, 0x7f
s_cbranch_scc0 L_spin_g3
s_branch L_ok_g3
L_redo0:
s_nop 15
v_mfma_f32_32x32x16_bf16 v[96:111], a[168:171], v[40:43], 0
v_mfma_f32_32x32x16_bf16 v[184:199], a[136:139], v[40:43], 0
s_nop 11
v_cndmask_b32 v96, v184, v96, s[48:49]
v_cndmask_b32 v97, v185, v97, s[50:51]
v_cndmask_b32 v98, v186, v98, s[52:53]
v_cndmask_b32 v99, v187, v99, s[54:55]
v_cndmask_b32 v100, v188, v100, s[56:57]
v_cndmask_b32 v101, v189, v101, s[58:59]
v_cndmask_b32 v102, v190, v102, s[60:61]
v_cndmask_b32 v103, v191, v103, s[62:63]
v_cndmask_b32 v104, v192, v104, s[64:65]
v_cndmask_b32 v105, v193, v105, s[66:67]
v_cndmask_b32 v106, v194, v106, s[68:69]
v_cndmask_b32 v107, v195, v107, s[70:71]
v_cndmask_b32 v108, v196, v108, s[72:73]
v_cndmask_b32 v109, v197, v109, s[74:75]
v_cndmask_b32 v110, v198, v110, s[76:77]
v_cndmask_b32 v111, v199, v111, s[78:79]
v_max_f32 v52, v96, v97
v_max3_f32 v52, v98, v99, v52
v_max3_f32 v52, v100, v101, v52
v_max3_f32 v52, v102, v103, v52
v_max3_f32 v52, v104, v105, v52
v_max3_f32 v52, v106, v107, v52
v_max3_f32 v52, v108, v109, v52
v_max3_f32 v52, v110, v111, v52
v_mfma_f32_32x32x16_bf16 v[184:199], a[140:143], v[40:43], 0
s_nop 11
v_max3_f32 v52, v184, v185, v52
v_max3_f32 v52, v186, v187, v52
v_max3_f32 v52, v188, v189, v52
v_max3_f32 v52, v190, v191, v52
v_max3_f32 v52, v192, v193, v52
v_max3_f32 v52, v194, v195, v52
v_max3_f32 v52, v196, v197, v52
v_max3_f32 v52, v198, v199, v52
v_mfma_f32_32x32x16_bf16 v[184:199], a[144:147], v[40:43], 0
s_nop 11
v_max3_f32 v52, v184, v185, v52
v_max3_f32 v52, v186, v187, v52
v_max3_f32 v52, v188, v189, v52
v_max3_f32 v52, v190, v191, v52
v_max3_f32 v52, v192, v193, v52
v_max3_f32 v52, v194, v195, v52
v_max3_f32 v52, v196, v197, v52
v_max3_f32 v52, v198, v199, v52
v_mfma_f32_32x32x16_bf16 v[184:199], a[148:151], v[40:43], 0
s_nop 11
v_max3_f32 v52, v184, v185, v52
v_max3_f32 v52, v186, v187, v52
v_max3_f32 v52, v188, v189, v52
v_max3_f32 v52, v190, v191, v52
v_max3_f32 v52, v192, v193, v52
v_max3_f32 v52, v194, v195, v52
v_max3_f32 v52, v196, v197, v52
v_max3_f32 v52, v198, v199, v52
v_mfma_f32_32x32x16_bf16 v[184:199], a[152:155], v[40:43], 0
s_nop 11
v_max3_f32 v52, v184, v185, v52
v_max3_f32 v52, v186, v187, v52
v_max3_f32 v52, v188, v189, v52
v_max3_f32 v52, v190, v191, v52
v_max3_f32 v52, v192, v193, v52
v_max3_f32 v52, v194, v195, v52
v_max3_f32 v52, v196, v197, v52
v_max3_f32 v52, v198, v199, v52
v_mfma_f32_32x32x16_bf16 v[184:199], a[156:159], v[40:43], 0
s_nop 11
v_max3_f32 v52, v184, v185, v52
v_max3_f32 v52, v186, v187, v52
v_max3_f32 v52, v188, v189, v52
v_max3_f32 v52, v190, v191, v52
v_max3_f32 v52, v192, v193, v52
v_max3_f32 v52, v194, v195, v52
v_max3_f32 v52, v196, v197, v52
v_max3_f32 v52, v198, v199, v52
v_mfma_f32_32x32x16_bf16 v[184:199], a[160:163], v[40:43], 0
s_nop 11
v_max3_f32 v52, v184, v185, v52
v_max3_f32 v52, v186, v187, v52
v_max3_f32 v52, v188, v189, v52
v_max3_f32 v52, v190, v191, v52
v_max3_f32 v52, v192, v193, v52
v_max3_f32 v52, v194, v195, v52
v_max3_f32 v52, v196, v197, v52
v_max3_f32 v52, v198, v199, v52
v_mfma_f32_32x32x16_bf16 v[184:199], a[164:167], v[40:43], 0
s_nop 11
v_max3_f32 v52, v184, v185, v52
v_max3_f32 v52, v186, v187, v52
v_max3_f32 v52, v188, v189, v52
v_max3_f32 v52, v190, v191, v52
v_max3_f32 v52, v192, v193, v52
v_max3_f32 v52, v194, v195, v52
v_max3_f32 v52, v196, v197, v52
v_max3_f32 v52, v198, v199, v52
v_mov_b32 v53, v52
s_nop 1
v_permlane32_swap_b32 v52, v53
v_max_f32 v52, v52, v53
v_sub_f32 v96, v96, v52
v_sub_f32 v97, v97, v52
v_sub_f32 v98, v98, v52
v_sub_f32 v99, v99, v52
v_sub_f32 v100, v100, v52
v_sub_f32 v101, v101, v52
v_sub_f32 v102, v102, v52
v_sub_f32 v103, v103, v52
v_sub_f32 v104, v104, v52
v_sub_f32 v105, v105, v52
v_sub_f32 v106, v106, v52
v_sub_f32 v107, v107, v52
v_sub_f32 v108, v108, v52
v_sub_f32 v109, v109, v52
v_sub_f32 v110, v110, v52
v_sub_f32 v111, v111, v52
v_exp_f32 v96, v96
v_exp_f32 v97, v97
v_exp_f32 v98, v98
v_exp_f32 v99, v99
v_cvt_pk_bf16_f32 v208, v96, v97
v_exp_f32 v100, v100
v_exp_f32 v101, v101
v_cvt_pk_bf16_f32 v209, v98, v99
v_exp_f32 v102, v102
v_exp_f32 v103, v103
v_cvt_pk_bf16_f32 v210, v100, v101
v_exp_f32 v104, v104
v_exp_f32 v105, v105
v_cvt_pk_bf16_f32 v211, v102, v103
v_exp_f32 v106, v106
v_exp_f32 v107, v107
v_cvt_pk_bf16_f32 v212, v104, v105
v_exp_f32 v108, v108
v_exp_f32 v109, v109
v_cvt_pk_bf16_f32 v213, v106, v107
v_exp_f32 v110, v110
v_exp_f32 v111, v111
v_cvt_pk_bf16_f32 v214, v108, v109
v_and_b32 v200, v232, v208
v_cvt_pk_bf16_f32 v215, v110, v111
v_and_b32 v201, v233, v209
v_and_b32 v202, v234, v210
v_and_b32 v203, v235, v211
v_and_b32 v204, v236, v212
v_and_b32 v205, v237, v213
v_and_b32 v206, v238, v214
v_and_b32 v207, v239, v215
v_xor_b32 v208, v200, v208
v_xor_b32 v209, v201, v209
v_xor_b32 v210, v202, v210
v_xor_b32 v211, v203, v211
v_xor_b32 v212, v204, v212
v_xor_b32 v213, v205, v213
v_xor_b32 v214, v206, v214
v_xor_b32 v215, v207, v215
v_mfma_f32_32x32x16_bf16 v[144:159], a[240:243], v[200:203], 0
v_mfma_f32_32x32x16_bf16 v[144:159], a[244:247], v[204:207], v[144:159]
v_mfma_f32_32x32x16_bf16 v[144:159], a[176:179], v[208:211], v[144:159]
v_mfma_f32_32x32x16_bf16 v[144:159], a[180:183], v[212:215], v[144:159]
v_mfma_f32_32x32x16_bf16 v[184:199], a[140:143], v[40:43], 0
s_nop 11
v_sub_f32 v184, v184, v52
v_sub_f32 v185, v185, v52
v_sub_f32 v186, v186, v52
v_sub_f32 v187, v187, v52
v_sub_f32 v188, v188, v52
v_sub_f32 v189, v189, v52
v_sub_f32 v190, v190, v52
v_sub_f32 v191, v191, v52
v_sub_f32 v192, v192, v52
v_sub_f32 v193, v193, v52
v_sub_f32 v194, v194, v52
v_sub_f32 v195, v195, v52
v_sub_f32 v196, v196, v52
v_sub_f32 v197, v197, v52
v_sub_f32 v198, v198, v52
v_sub_f32 v199, v199, v52
v_exp_f32 v184, v184
v_exp_f32 v185, v185
v_exp_f32 v186, v186
v_exp_f32 v187, v187
v_cvt_pk_bf16_f32 v200, v184, v185
v_exp_f32 v188, v188
v_exp_f32 v189, v189
v_cvt_pk_bf16_f32 v201, v186, v187
v_exp_f32 v190, v190
v_exp_f32 v191, v191
v_cvt_pk_bf16_f32 v202, v188, v189
v_exp_f32 v192, v192
v_exp_f32 v193, v193
v_cvt_pk_bf16_f32 v203, v190, v191
v_exp_f32 v194, v194
v_exp_f32 v195, v195
v_cvt_pk_bf16_f32 v204, v192, v193
v_exp_f32 v196, v196
v_exp_f32 v197, v197
v_cvt_pk_bf16_f32 v205, v194, v195
v_exp_f32 v198, v198
v_exp_f32 v199, v199
v_cvt_pk_bf16_f32 v206, v196, v197
v_cvt_pk_bf16_f32 v207, v198, v199
v_mfma_f32_32x32x16_bf16 v[144:159], a[184:187], v[200:203], v[144:159]
s_nop 0
v_mfma_f32_32x32x16_bf16 v[144:159], a[188:191], v[204:207], v[144:159]
v_mfma_f32_32x32x16_bf16 v[184:199], a[144:147], v[40:43], 0
s_nop 11
v_sub_f32 v184, v184, v52
v_sub_f32 v185, v185, v52
v_sub_f32 v186, v186, v52
v_sub_f32 v187, v187, v52
v_sub_f32 v188, v188, v52
v_sub_f32 v189, v189, v52
v_sub_f32 v190, v190, v52
v_sub_f32 v191, v191, v52
v_sub_f32 v192, v192, v52
v_sub_f32 v193, v193, v52
v_sub_f32 v194, v194, v52
v_sub_f32 v195, v195, v52
v_sub_f32 v196, v196, v52
v_sub_f32 v197, v197, v52
v_sub_f32 v198, v198, v52
v_sub_f32 v199, v199, v52
v_exp_f32 v184, v184
v_exp_f32 v185, v185
v_exp_f32 v186, v186
v_exp_f32 v187, v187
v_cvt_pk_bf16_f32 v200, v184, v185
v_exp_f32 v188, v188
v_exp_f32 v189, v189
v_cvt_pk_bf16_f32 v201, v186, v187
v_exp_f32 v190, v190
v_exp_f32 v191, v191
v_cvt_pk_bf16_f32 v202, v188, v189
v_exp_f32 v192, v192
v_exp_f32 v193, v193
v_cvt_pk_bf16_f32 v203, v190, v191
v_exp_f32 v194, v194
v_exp_f32 v195, v195
v_cvt_pk_bf16_f32 v204, v192, v193
v_exp_f32 v196, v196
v_exp_f32 v197, v197
v_cvt_pk_bf16_f32 v205, v194, v195
v_exp_f32 v198, v198
v_exp_f32 v199, v199
v_cvt_pk_bf16_f32 v206, v196, v197
v_cvt_pk_bf16_f32 v207, v198, v199
v_mfma_f32_32x32x16_bf16 v[144:159], a[192:195], v[200:203], v[144:159]
s_nop 0
v_mfma_f32_32x32x16_bf16 v[144:159], a[196:199], v[204:207], v[144:159]
v_mfma_f32_32x32x16_bf16 v[184:199], a[148:151], v[40:43], 0
s_nop 11
v_sub_f32 v184, v184, v52
v_sub_f32 v185, v185, v52
v_sub_f32 v186, v186, v52
v_sub_f32 v187, v187, v52
v_sub_f32 v188, v188, v52
v_sub_f32 v189, v189, v52
v_sub_f32 v190, v190, v52
v_sub_f32 v191, v191, v52
v_sub_f32 v192, v192, v52
v_sub_f32 v193, v193, v52
v_sub_f32 v194, v194, v52
v_sub_f32 v195, v195, v52
v_sub_f32 v196, v196, v52
v_sub_f32 v197, v197, v52
v_sub_f32 v198, v198, v52
v_sub_f32 v199, v199, v52
v_exp_f32 v184, v184
v_exp_f32 v185, v185
v_exp_f32 v186, v186
v_exp_f32 v187, v187
v_cvt_pk_bf16_f32 v200, v184, v185
v_exp_f32 v188, v188
v_exp_f32 v189, v189
v_cvt_pk_bf16_f32 v201, v186, v187
v_exp_f32 v190, v190
v_exp_f32 v191, v191
v_cvt_pk_bf16_f32 v202, v188, v189
v_exp_f32 v192, v192
v_exp_f32 v193, v193
v_cvt_pk_bf16_f32 v203, v190, v191
v_exp_f32 v194, v194
v_exp_f32 v195, v195
v_cvt_pk_bf16_f32 v204, v192, v193
v_exp_f32 v196, v196
v_exp_f32 v197, v197
v_cvt_pk_bf16_f32 v205, v194, v195
v_exp_f32 v198, v198
v_exp_f32 v199, v199
v_cvt_pk_bf16_f32 v206, v196, v197
v_cvt_pk_bf16_f32 v207, v198, v199
v_mfma_f32_32x32x16_bf16 v[144:159], a[200:203], v[200:203], v[144:159]
s_nop 0
v_mfma_f32_32x32x16_bf16 v[144:159], a[204:207], v[204:207], v[144:159]
v_mfma_f32_32x32x16_bf16 v[184:199], a[152:155], v[40:43], 0
s_nop 11
v_sub_f32 v184, v184, v52
v_sub_f32 v185, v185, v52
v_sub_f32 v186, v186, v52
v_sub_f32 v187, v187, v52
v_sub_f32 v188, v188, v52
v_sub_f32 v189, v189, v52
v_sub_f32 v190, v190, v52
v_sub_f32 v191, v191, v52
v_sub_f32 v192, v192, v52
v_sub_f32 v193, v193, v52
v_sub_f32 v194, v194, v52
v_sub_f32 v195, v195, v52
v_sub_f32 v196, v196, v52
v_sub_f32 v197, v197, v52
v_sub_f32 v198, v198, v52
v_sub_f32 v199, v199, v52
v_exp_f32 v184, v184
v_exp_f32 v185, v185
v_exp_f32 v186, v186
v_exp_f32 v187, v187
v_cvt_pk_bf16_f32 v200, v184, v185
v_exp_f32 v188, v188
v_exp_f32 v189, v189
v_cvt_pk_bf16_f32 v201, v186, v187
v_exp_f32 v190, v190
v_exp_f32 v191, v191
v_cvt_pk_bf16_f32 v202, v188, v189
v_exp_f32 v192, v192
v_exp_f32 v193, v193
v_cvt_pk_bf16_f32 v203, v190, v191
v_exp_f32 v194, v194
v_exp_f32 v195, v195
v_cvt_pk_bf16_f32 v204, v192, v193
v_exp_f32 v196, v196
v_exp_f32 v197, v197
v_cvt_pk_bf16_f32 v205, v194, v195
v_exp_f32 v198, v198
v_exp_f32 v199, v199
v_cvt_pk_bf16_f32 v206, v196, v197
v_cvt_pk_bf16_f32 v207, v198, v199
v_mfma_f32_32x32x16_bf16 v[144:159], a[208:211], v[200:203], v[144:159]
s_nop 0
v_mfma_f32_32x32x16_bf16 v[144:159], a[212:215], v[204:207], v[144:159]
v_mfma_f32_32x32x16_bf16 v[184:199], a[156:159], v[40:43], 0
s_nop 11
v_sub_f32 v184, v184, v52
v_sub_f32 v185, v185, v52
v_sub_f32 v186, v186, v52
v_sub_f32 v187, v187, v52
v_sub_f32 v188, v188, v52
v_sub_f32 v189, v189, v52
v_sub_f32 v190, v190, v52
v_sub_f32 v191, v191, v52
v_sub_f32 v192, v192, v52
v_sub_f32 v193, v193, v52
v_sub_f32 v194, v194, v52
v_sub_f32 v195, v195, v52
v_sub_f32 v196, v196, v52
v_sub_f32 v197, v197, v52
v_sub_f32 v198, v198, v52
v_sub_f32 v199, v199, v52
v_exp_f32 v184, v184
v_exp_f32 v185, v185
v_exp_f32 v186, v186
v_exp_f32 v187, v187
v_cvt_pk_bf16_f32 v200, v184, v185
v_exp_f32 v188, v188
v_exp_f32 v189, v189
v_cvt_pk_bf16_f32 v201, v186, v187
v_exp_f32 v190, v190
v_exp_f32 v191, v191
v_cvt_pk_bf16_f32 v202, v188, v189
v_exp_f32 v192, v192
v_exp_f32 v193, v193
v_cvt_pk_bf16_f32 v203, v190, v191
v_exp_f32 v194, v194
v_exp_f32 v195, v195
v_cvt_pk_bf16_f32 v204, v192, v193
v_exp_f32 v196, v196
v_exp_f32 v197, v197
v_cvt_pk_bf16_f32 v205, v194, v195
v_exp_f32 v198, v198
v_exp_f32 v199, v199
v_cvt_pk_bf16_f32 v206, v196, v197
v_cvt_pk_bf16_f32 v207, v198, v199
v_mfma_f32_32x32x16_bf16 v[144:159], a[216:219], v[200:203], v[144:159]
s_nop 0
v_mfma_f32_32x32x16_bf16 v[144:159], a[220:223], v[204:207], v[144:159]
v_mfma_f32_32x32x16_bf16 v[184:199], a[160:163], v[40:43], 0
s_nop 11
v_sub_f32 v184, v184, v52
v_sub_f32 v185, v185, v52
v_sub_f32 v186, v186, v52
v_sub_f32 v187, v187, v52
v_sub_f32 v188, v188, v52
v_sub_f32 v189, v189, v52
v_sub_f32 v190, v190, v52
v_sub_f32 v191, v191, v52
v_sub_f32 v192, v192, v52
v_sub_f32 v193, v193, v52
v_sub_f32 v194, v194, v52
v_sub_f32 v195, v195, v52
v_sub_f32 v196, v196, v52
v_sub_f32 v197, v197, v52
v_sub_f32 v198, v198, v52
v_sub_f32 v199, v199, v52
v_exp_f32 v184, v184
v_exp_f32 v185, v185
v_exp_f32 v186, v186
v_exp_f32 v187, v187
v_cvt_pk_bf16_f32 v200, v184, v185
v_exp_f32 v188, v188
v_exp_f32 v189, v189
v_cvt_pk_bf16_f32 v201, v186, v187
v_exp_f32 v190, v190
v_exp_f32 v191, v191
v_cvt_pk_bf16_f32 v202, v188, v189
v_exp_f32 v192, v192
v_exp_f32 v193, v193
v_cvt_pk_bf16_f32 v203, v190, v191
v_exp_f32 v194, v194
v_exp_f32 v195, v195
v_cvt_pk_bf16_f32 v204, v192, v193
v_exp_f32 v196, v196
v_exp_f32 v197, v197
v_cvt_pk_bf16_f32 v205, v194, v195
v_exp_f32 v198, v198
v_exp_f32 v199, v199
v_cvt_pk_bf16_f32 v206, v196, v197
v_cvt_pk_bf16_f32 v207, v198, v199
v_mfma_f32_32x32x16_bf16 v[144:159], a[224:227], v[200:203], v[144:159]
s_nop 0
v_mfma_f32_32x32x16_bf16 v[144:159], a[228:231], v[204:207], v[144:159]
v_mfma_f32_32x32x16_bf16 v[184:199], a[164:167], v[40:43], 0
s_nop 11
v_sub_f32 v184, v184, v52
v_sub_f32 v185, v185, v52
v_sub_f32 v186, v186, v52
v_sub_f32 v187, v187, v52
v_sub_f32 v188, v188, v52
v_sub_f32 v189, v189, v52
v_sub_f32 v190, v190, v52
v_sub_f32 v191, v191, v52
v_sub_f32 v192, v192, v52
v_sub_f32 v193, v193, v52
v_sub_f32 v194, v194, v52
v_sub_f32 v195, v195, v52
v_sub_f32 v196, v196, v52
v_sub_f32 v197, v197, v52
v_sub_f32 v198, v198, v52
v_sub_f32 v199, v199, v52
v_exp_f32 v184, v184
v_exp_f32 v185, v185
v_exp_f32 v186, v186
v_exp_f32 v187, v187
v_cvt_pk_bf16_f32 v200, v184, v185
v_exp_f32 v188, v188
v_exp_f32 v189, v189
v_cvt_pk_bf16_f32 v201, v186, v187
v_exp_f32 v190, v190
v_exp_f32 v191, v191
v_cvt_pk_bf16_f32 v202, v188, v189
v_exp_f32 v192, v192
v_exp_f32 v193, v193
v_cvt_pk_bf16_f32 v203, v190, v191
v_exp_f32 v194, v194
v_exp_f32 v195, v195
v_cvt_pk_bf16_f32 v204, v192, v193
v_exp_f32 v196, v196
v_exp_f32 v197, v197
v_cvt_pk_bf16_f32 v205, v194, v195
v_exp_f32 v198, v198
v_exp_f32 v199, v199
v_cvt_pk_bf16_f32 v206, v196, v197
v_cvt_pk_bf16_f32 v207, v198, v199
v_mfma_f32_32x32x16_bf16 v[144:159], a[232:235], v[200:203], v[144:159]
s_nop 0
v_mfma_f32_32x32x16_bf16 v[144:159], a[236:239], v[204:207], v[144:159]
s_nop 15
s_branch L_fin0
L_redo1:
s_nop 15
v_mfma_f32_32x32x16_bf16 v[96:111], a[172:175], v[44:47], 0
v_mfma_f32_32x32x16_bf16 v[184:199], a[140:143], v[44:47], 0
s_nop 11
v_cndmask_b32 v96, v184, v96, s[48:49]
v_cndmask_b32 v97, v185, v97, s[50:51]
v_cndmask_b32 v98, v186, v98, s[52:53]
v_cndmask_b32 v99, v187, v99, s[54:55]
v_cndmask_b32 v100, v188, v100, s[56:57]
v_cndmask_b32 v101, v189, v101, s[58:59]
v_cndmask_b32 v102, v190, v102, s[60:61]
v_cndmask_b32 v103, v191, v103, s[62:63]
v_cndmask_b32 v104, v192, v104, s[64:65]
v_cndmask_b32 v105, v193, v105, s[66:67]
v_cndmask_b32 v106, v194, v106, s[68:69]
v_cndmask_b32 v107, v195, v107, s[70:71]
v_cndmask_b32 v108, v196, v108, s[72:73]
v_cndmask_b32 v109, v197, v109, s[74:75]
v_cndmask_b32 v110, v198, v110, s[76:77]
v_cndmask_b32 v111, v199, v111, s[78:79]
v_max_f32 v52, v96, v97
v_max3_f32 v52, v98, v99, v52
v_max3_f32 v52, v100, v101, v52
v_max3_f32 v52, v102, v103, v52
v_max3_f32 v52, v104, v105, v52
v_max3_f32 v52, v106, v107, v52
v_max3_f32 v52, v108, v109, v52
v_max3_f32 v52, v110, v111, v52
v_mfma_f32_32x32x16_bf16 v[184:199], a[144:147], v[44:47], 0
s_nop 11
v_max3_f32 v52, v184, v185, v52
v_max3_f32 v52, v186, v187, v52
v_max3_f32 v52, v188, v189, v52
v_max3_f32 v52, v190, v191, v52
v_max3_f32 v52, v192, v193, v52
v_max3_f32 v52, v194, v195, v52
v_max3_f32 v52, v196, v197, v52
v_max3_f32 v52, v198, v199, v52
v_mfma_f32_32x32x16_bf16 v[184:199], a[148:151], v[44:47], 0
s_nop 11
v_max3_f32 v52, v184, v185, v52
v_max3_f32 v52, v186, v187, v52
v_max3_f32 v52, v188, v189, v52
v_max3_f32 v52, v190, v191, v52
v_max3_f32 v52, v192, v193, v52
v_max3_f32 v52, v194, v195, v52
v_max3_f32 v52, v196, v197, v52
v_max3_f32 v52, v198, v199, v52
v_mfma_f32_32x32x16_bf16 v[184:199], a[152:155], v[44:47], 0
s_nop 11
v_max3_f32 v52, v184, v185, v52
v_max3_f32 v52, v186, v187, v52
v_max3_f32 v52, v188, v189, v52
v_max3_f32 v52, v190, v191, v52
v_max3_f32 v52, v192, v193, v52
v_max3_f32 v52, v194, v195, v52
v_max3_f32 v52, v196, v197, v52
v_max3_f32 v52, v198, v199, v52
v_mfma_f32_32x32x16_bf16 v[184:199], a[156:159], v[44:47], 0
s_nop 11
v_max3_f32 v52, v184, v185, v52
v_max3_f32 v52, v186, v187, v52
v_max3_f32 v52, v188, v189, v52
v_max3_f32 v52, v190, v191, v52
v_max3_f32 v52, v192, v193, v52
v_max3_f32 v52, v194, v195, v52
v_max3_f32 v52, v196, v197, v52
v_max3_f32 v52, v198, v199, v52
v_mfma_f32_32x32x16_bf16 v[184:199], a[160:163], v[44:47], 0
s_nop 11
v_max3_f32 v52, v184, v185, v52
v_max3_f32 v52, v186, v187, v52
v_max3_f32 v52, v188, v189, v52
v_max3_f32 v52, v190, v191, v52
v_max3_f32 v52, v192, v193, v52
v_max3_f32 v52, v194, v195, v52
v_max3_f32 v52, v196, v197, v52
v_max3_f32 v52, v198, v199, v52
v_mfma_f32_32x32x16_bf16 v[184:199], a[164:167], v[44:47], 0
s_nop 11
v_max3_f32 v52, v184, v185, v52
v_max3_f32 v52, v186, v187, v52
v_max3_f32 v52, v188, v189, v52
v_max3_f32 v52, v190, v191, v52
v_max3_f32 v52, v192, v193, v52
v_max3_f32 v52, v194, v195, v52
v_max3_f32 v52, v196, v197, v52
v_max3_f32 v52, v198, v199, v52
v_mfma_f32_32x32x16_bf16 v[184:199], a[168:171], v[44:47], 0
s_nop 11
v_max3_f32 v52, v184, v185, v52
v_max3_f32 v52, v186, v187, v52
v_max3_f32 v52, v188, v189, v52
v_max3_f32 v52, v190, v191, v52
v_max3_f32 v52, v192, v193, v52
v_max3_f32 v52, v194, v195, v52
v_max3_f32 v52, v196, v197, v52
v_max3_f32 v52, v198, v199, v52
v_mov_b32 v53, v52
s_nop 1
v_permlane32_swap_b32 v52, v53
v_max_f32 v52, v52, v53
v_sub_f32 v96, v96, v52
v_sub_f32 v97, v97, v52
v_sub_f32 v98, v98, v52
v_sub_f32 v99, v99, v52
v_sub_f32 v100, v100, v52
v_sub_f32 v101, v101, v52
v_sub_f32 v102, v102, v52
v_sub_f32 v103, v103, v52
v_sub_f32 v104, v104, v52
v_sub_f32 v105, v105, v52
v_sub_f32 v106, v106, v52
v_sub_f32 v107, v107, v52
v_sub_f32 v108, v108, v52
v_sub_f32 v109, v109, v52
v_sub_f32 v110, v110, v52
v_sub_f32 v111, v111, v52
v_exp_f32 v96, v96
v_exp_f32 v97, v97
v_exp_f32 v98, v98
v_exp_f32 v99, v99
v_cvt_pk_bf16_f32 v208, v96, v97
v_exp_f32 v100, v100
v_exp_f32 v101, v101
v_cvt_pk_bf16_f32 v209, v98, v99
v_exp_f32 v102, v102
v_exp_f32 v103, v103
v_cvt_pk_bf16_f32 v210, v100, v101
v_exp_f32 v104, v104
v_exp_f32 v105, v105
v_cvt_pk_bf16_f32 v211, v102, v103
v_exp_f32 v106, v106
v_exp_f32 v107, v107
v_cvt_pk_bf16_f32 v212, v104, v105
v_exp_f32 v108, v108
v_exp_f32 v109, v109
v_cvt_pk_bf16_f32 v213, v106, v107
v_exp_f32 v110, v110
v_exp_f32 v111, v111
v_cvt_pk_bf16_f32 v214, v108, v109
v_and_b32 v200, v232, v208
v_cvt_pk_bf16_f32 v215, v110, v111
v_and_b32 v201, v233, v209
v_and_b32 v202, v234, v210
v_and_b32 v203, v235, v211
v_and_b32 v204, v236, v212
v_and_b32 v205, v237, v213
v_and_b32 v206, v238, v214
v_and_b32 v207, v239, v215
v_xor_b32 v208, v200, v208
v_xor_b32 v209, v201, v209
v_xor_b32 v210, v202, v210
v_xor_b32 v211, v203, v211
v_xor_b32 v212, v204, v212
v_xor_b32 v213, v205, v213
v_xor_b32 v214, v206, v214
v_xor_b32 v215, v207, v215
v_mfma_f32_32x32x16_bf16 v[128:143], a[248:251], v[200:203], 0
v_mfma_f32_32x32x16_bf16 v[128:143], a[252:255], v[204:207], v[128:143]
v_mfma_f32_32x32x16_bf16 v[128:143], a[184:187], v[208:211], v[128:143]
v_mfma_f32_32x32x16_bf16 v[128:143], a[188:191], v[212:215], v[128:143]
v_mfma_f32_32x32x16_bf16 v[184:199], a[144:147], v[44:47], 0
s_nop 11
v_sub_f32 v184, v184, v52
v_sub_f32 v185, v185, v52
v_sub_f32 v186, v186, v52
v_sub_f32 v187, v187, v52
v_sub_f32 v188, v188, v52
v_sub_f32 v189, v189, v52
v_sub_f32 v190, v190, v52
v_sub_f32 v191, v191, v52
v_sub_f32 v192, v192, v52
v_sub_f32 v193, v193, v52
v_sub_f32 v194, v194, v52
v_sub_f32 v195, v195, v52
v_sub_f32 v196, v196, v52
v_sub_f32 v197, v197, v52
v_sub_f32 v198, v198, v52
v_sub_f32 v199, v199, v52
v_exp_f32 v184, v184
v_exp_f32 v185, v185
v_exp_f32 v186, v186
v_exp_f32 v187, v187
v_cvt_pk_bf16_f32 v200, v184, v185
v_exp_f32 v188, v188
v_exp_f32 v189, v189
v_cvt_pk_bf16_f32 v201, v186, v187
v_exp_f32 v190, v190
v_exp_f32 v191, v191
v_cvt_pk_bf16_f32 v202, v188, v189
v_exp_f32 v192, v192
v_exp_f32 v193, v193
v_cvt_pk_bf16_f32 v203, v190, v191
v_exp_f32 v194, v194
v_exp_f32 v195, v195
v_cvt_pk_bf16_f32 v204, v192, v193
v_exp_f32 v196, v196
v_exp_f32 v197, v197
v_cvt_pk_bf16_f32 v205, v194, v195
v_exp_f32 v198, v198
v_exp_f32 v199, v199
v_cvt_pk_bf16_f32 v206, v196, v197
v_cvt_pk_bf16_f32 v207, v198, v199
v_mfma_f32_32x32x16_bf16 v[128:143], a[192:195], v[200:203], v[128:143]
s_nop 0
v_mfma_f32_32x32x16_bf16 v[128:143], a[196:199], v[204:207], v[128:143]
v_mfma_f32_32x32x16_bf16 v[184:199], a[148:151], v[44:47], 0
s_nop 11
v_sub_f32 v184, v184, v52
v_sub_f32 v185, v185, v52
v_sub_f32 v186, v186, v52
v_sub_f32 v187, v187, v52
v_sub_f32 v188, v188, v52
v_sub_f32 v189, v189, v52
v_sub_f32 v190, v190, v52
v_sub_f32 v191, v191, v52
v_sub_f32 v192, v192, v52
v_sub_f32 v193, v193, v52
v_sub_f32 v194, v194, v52
v_sub_f32 v195, v195, v52
v_sub_f32 v196, v196, v52
v_sub_f32 v197, v197, v52
v_sub_f32 v198, v198, v52
v_sub_f32 v199, v199, v52
v_exp_f32 v184, v184
v_exp_f32 v185, v185
v_exp_f32 v186, v186
v_exp_f32 v187, v187
v_cvt_pk_bf16_f32 v200, v184, v185
v_exp_f32 v188, v188
v_exp_f32 v189, v189
v_cvt_pk_bf16_f32 v201, v186, v187
v_exp_f32 v190, v190
v_exp_f32 v191, v191
v_cvt_pk_bf16_f32 v202, v188, v189
v_exp_f32 v192, v192
v_exp_f32 v193, v193
v_cvt_pk_bf16_f32 v203, v190, v191
v_exp_f32 v194, v194
v_exp_f32 v195, v195
v_cvt_pk_bf16_f32 v204, v192, v193
v_exp_f32 v196, v196
v_exp_f32 v197, v197
v_cvt_pk_bf16_f32 v205, v194, v195
v_exp_f32 v198, v198
v_exp_f32 v199, v199
v_cvt_pk_bf16_f32 v206, v196, v197
v_cvt_pk_bf16_f32 v207, v198, v199
v_mfma_f32_32x32x16_bf16 v[128:143], a[200:203], v[200:203], v[128:143]
s_nop 0
v_mfma_f32_32x32x16_bf16 v[128:143], a[204:207], v[204:207], v[128:143]
v_mfma_f32_32x32x16_bf16 v[184:199], a[152:155], v[44:47], 0
s_nop 11
v_sub_f32 v184, v184, v52
v_sub_f32 v185, v185, v52
v_sub_f32 v186, v186, v52
v_sub_f32 v187, v187, v52
v_sub_f32 v188, v188, v52
v_sub_f32 v189, v189, v52
v_sub_f32 v190, v190, v52
v_sub_f32 v191, v191, v52
v_sub_f32 v192, v192, v52
v_sub_f32 v193, v193, v52
v_sub_f32 v194, v194, v52
v_sub_f32 v195, v195, v52
v_sub_f32 v196, v196, v52
v_sub_f32 v197, v197, v52
v_sub_f32 v198, v198, v52
v_sub_f32 v199, v199, v52
v_exp_f32 v184, v184
v_exp_f32 v185, v185
v_exp_f32 v186, v186
v_exp_f32 v187, v187
v_cvt_pk_bf16_f32 v200, v184, v185
v_exp_f32 v188, v188
v_exp_f32 v189, v189
v_cvt_pk_bf16_f32 v201, v186, v187
v_exp_f32 v190, v190
v_exp_f32 v191, v191
v_cvt_pk_bf16_f32 v202, v188, v189
v_exp_f32 v192, v192
v_exp_f32 v193, v193
v_cvt_pk_bf16_f32 v203, v190, v191
v_exp_f32 v194, v194
v_exp_f32 v195, v195
v_cvt_pk_bf16_f32 v204, v192, v193
v_exp_f32 v196, v196
v_exp_f32 v197, v197
v_cvt_pk_bf16_f32 v205, v194, v195
v_exp_f32 v198, v198
v_exp_f32 v199, v199
v_cvt_pk_bf16_f32 v206, v196, v197
v_cvt_pk_bf16_f32 v207, v198, v199
v_mfma_f32_32x32x16_bf16 v[128:143], a[208:211], v[200:203], v[128:143]
s_nop 0
v_mfma_f32_32x32x16_bf16 v[128:143], a[212:215], v[204:207], v[128:143]
v_mfma_f32_32x32x16_bf16 v[184:199], a[156:159], v[44:47], 0
s_nop 11
v_sub_f32 v184, v184, v52
v_sub_f32 v185, v185, v52
v_sub_f32 v186, v186, v52
v_sub_f32 v187, v187, v52
v_sub_f32 v188, v188, v52
v_sub_f32 v189, v189, v52
v_sub_f32 v190, v190, v52
v_sub_f32 v191, v191, v52
v_sub_f32 v192, v192, v52
v_sub_f32 v193, v193, v52
v_sub_f32 v194, v194, v52
v_sub_f32 v195, v195, v52
v_sub_f32 v196, v196, v52
v_sub_f32 v197, v197, v52
v_sub_f32 v198, v198, v52
v_sub_f32 v199, v199, v52
v_exp_f32 v184, v184
v_exp_f32 v185, v185
v_exp_f32 v186, v186
v_exp_f32 v187, v187
v_cvt_pk_bf16_f32 v200, v184, v185
v_exp_f32 v188, v188
v_exp_f32 v189, v189
v_cvt_pk_bf16_f32 v201, v186, v187
v_exp_f32 v190, v190
v_exp_f32 v191, v191
v_cvt_pk_bf16_f32 v202, v188, v189
v_exp_f32 v192, v192
v_exp_f32 v193, v193
v_cvt_pk_bf16_f32 v203, v190, v191
v_exp_f32 v194, v194
v_exp_f32 v195, v195
v_cvt_pk_bf16_f32 v204, v192, v193
v_exp_f32 v196, v196
v_exp_f32 v197, v197
v_cvt_pk_bf16_f32 v205, v194, v195
v_exp_f32 v198, v198
v_exp_f32 v199, v199
v_cvt_pk_bf16_f32 v206, v196, v197
v_cvt_pk_bf16_f32 v207, v198, v199
v_mfma_f32_32x32x16_bf16 v[128:143], a[216:219], v[200:203], v[128:143]
s_nop 0
v_mfma_f32_32x32x16_bf16 v[128:143], a[220:223], v[204:207], v[128:143]
v_mfma_f32_32x32x16_bf16 v[184:199], a[160:163], v[44:47], 0
s_nop 11
v_sub_f32 v184, v184, v52
v_sub_f32 v185, v185, v52
v_sub_f32 v186, v186, v52
v_sub_f32 v187, v187, v52
v_sub_f32 v188, v188, v52
v_sub_f32 v189, v189, v52
v_sub_f32 v190, v190, v52
v_sub_f32 v191, v191, v52
v_sub_f32 v192, v192, v52
v_sub_f32 v193, v193, v52
v_sub_f32 v194, v194, v52
v_sub_f32 v195, v195, v52
v_sub_f32 v196, v196, v52
v_sub_f32 v197, v197, v52
v_sub_f32 v198, v198, v52
v_sub_f32 v199, v199, v52
v_exp_f32 v184, v184
v_exp_f32 v185, v185
v_exp_f32 v186, v186
v_exp_f32 v187, v187
v_cvt_pk_bf16_f32 v200, v184, v185
v_exp_f32 v188, v188
v_exp_f32 v189, v189
v_cvt_pk_bf16_f32 v201, v186, v187
v_exp_f32 v190, v190
v_exp_f32 v191, v191
v_cvt_pk_bf16_f32 v202, v188, v189
v_exp_f32 v192, v192
v_exp_f32 v193, v193
v_cvt_pk_bf16_f32 v203, v190, v191
v_exp_f32 v194, v194
v_exp_f32 v195, v195
v_cvt_pk_bf16_f32 v204, v192, v193
v_exp_f32 v196, v196
v_exp_f32 v197, v197
v_cvt_pk_bf16_f32 v205, v194, v195
v_exp_f32 v198, v198
v_exp_f32 v199, v199
v_cvt_pk_bf16_f32 v206, v196, v197
v_cvt_pk_bf16_f32 v207, v198, v199
v_mfma_f32_32x32x16_bf16 v[128:143], a[224:227], v[200:203], v[128:143]
s_nop 0
v_mfma_f32_32x32x16_bf16 v[128:143], a[228:231], v[204:207], v[128:143]
v_mfma_f32_32x32x16_bf16 v[184:199], a[164:167], v[44:47], 0
s_nop 11
v_sub_f32 v184, v184, v52
v_sub_f32 v185, v185, v52
v_sub_f32 v186, v186, v52
v_sub_f32 v187, v187, v52
v_sub_f32 v188, v188, v52
v_sub_f32 v189, v189, v52
v_sub_f32 v190, v190, v52
v_sub_f32 v191, v191, v52
v_sub_f32 v192, v192, v52
v_sub_f32 v193, v193, v52
v_sub_f32 v194, v194, v52
v_sub_f32 v195, v195, v52
v_sub_f32 v196, v196, v52
v_sub_f32 v197, v197, v52
v_sub_f32 v198, v198, v52
v_sub_f32 v199, v199, v52
v_exp_f32 v184, v184
v_exp_f32 v185, v185
v_exp_f32 v186, v186
v_exp_f32 v187, v187
v_cvt_pk_bf16_f32 v200, v184, v185
v_exp_f32 v188, v188
v_exp_f32 v189, v189
v_cvt_pk_bf16_f32 v201, v186, v187
v_exp_f32 v190, v190
v_exp_f32 v191, v191
v_cvt_pk_bf16_f32 v202, v188, v189
v_exp_f32 v192, v192
v_exp_f32 v193, v193
v_cvt_pk_bf16_f32 v203, v190, v191
v_exp_f32 v194, v194
v_exp_f32 v195, v195
v_cvt_pk_bf16_f32 v204, v192, v193
v_exp_f32 v196, v196
v_exp_f32 v197, v197
v_cvt_pk_bf16_f32 v205, v194, v195
v_exp_f32 v198, v198
v_exp_f32 v199, v199
v_cvt_pk_bf16_f32 v206, v196, v197
v_cvt_pk_bf16_f32 v207, v198, v199
v_mfma_f32_32x32x16_bf16 v[128:143], a[232:235], v[200:203], v[128:143]
s_nop 0
v_mfma_f32_32x32x16_bf16 v[128:143], a[236:239], v[204:207], v[128:143]
v_mfma_f32_32x32x16_bf16 v[184:199], a[168:171], v[44:47], 0
s_nop 11
v_sub_f32 v184, v184, v52
v_sub_f32 v185, v185, v52
v_sub_f32 v186, v186, v52
v_sub_f32 v187, v187, v52
v_sub_f32 v188, v188, v52
v_sub_f32 v189, v189, v52
v_sub_f32 v190, v190, v52
v_sub_f32 v191, v191, v52
v_sub_f32 v192, v192, v52
v_sub_f32 v193, v193, v52
v_sub_f32 v194, v194, v52
v_sub_f32 v195, v195, v52
v_sub_f32 v196, v196, v52
v_sub_f32 v197, v197, v52
v_sub_f32 v198, v198, v52
v_sub_f32 v199, v199, v52
v_exp_f32 v184, v184
v_exp_f32 v185, v185
v_exp_f32 v186, v186
v_exp_f32 v187, v187
v_cvt_pk_bf16_f32 v200, v184, v185
v_exp_f32 v188, v188
v_exp_f32 v189, v189
v_cvt_pk_bf16_f32 v201, v186, v187
v_exp_f32 v190, v190
v_exp_f32 v191, v191
v_cvt_pk_bf16_f32 v202, v188, v189
v_exp_f32 v192, v192
v_exp_f32 v193, v193
v_cvt_pk_bf16_f32 v203, v190, v191
v_exp_f32 v194, v194
v_exp_f32 v195, v195
v_cvt_pk_bf16_f32 v204, v192, v193
v_exp_f32 v196, v196
v_exp_f32 v197, v197
v_cvt_pk_bf16_f32 v205, v194, v195
v_exp_f32 v198, v198
v_exp_f32 v199, v199
v_cvt_pk_bf16_f32 v206, v196, v197
v_cvt_pk_bf16_f32 v207, v198, v199
v_mfma_f32_32x32x16_bf16 v[128:143], a[240:243], v[200:203], v[128:143]
s_nop 0
v_mfma_f32_32x32x16_bf16 v[128:143], a[244:247], v[204:207], v[128:143]
s_nop 15
s_branch L_fin1
.p2align 6
.type L_tab,@object
L_tab:
.long 0xffffffff
.long 0xfffffff0
.long 0xfffffffe
.long 0xffffffe0
.long 0xfffffffc
.long 0xffffffc0
.long 0xfffffff8
.long 0xffffff80
.long 0xffffff00
.long 0xfffff000
.long 0xfffffe00
.long 0xffffe000
.long 0xfffffc00
.long 0xffffc000
.long 0xfffff800
.long 0xffff8000
.long 0xffff0000
.long 0xfff00000
.long 0xfffe0000
.long 0xffe00000
.long 0xfffc0000
.long 0xffc00000
.long 0xfff80000
.long 0xff800000
.long 0xff000000
.long 0xf0000000
.long 0xfe000000
.long 0xe0000000
.long 0xfc000000
.long 0xc0000000
.long 0xf8000000
.long 0x80000000
.long 0x0000ffff
.long 0x0000ffff
.long 0xaaaaaaaa
.long 0xaaaaaaaa
.long 0xcccccccc
.long 0xcccccccc
.long 0x00000000
.long 0x00000000
.size L_tab, 160
.section .rodata,"a"
.p2align 6
.amdhsa_kernel sequential_preLN__sliding_block__glu_gated_glu__prompt_kernel
  .amdhsa_next_free_vgpr 512
  .amdhsa_next_free_sgpr 102
  .amdhsa_accum_offset 256
  .amdhsa_group_segment_fixed_size 0
  .amdhsa_kernarg_size 80
  .amdhsa_user_sgpr_count 2
  .amdhsa_user_sgpr_kernarg_segment_ptr 1
  .amdhsa_system_sgpr_workgroup_id_x 1
.end_amdhsa_kernel
```
